```python
import torch

def _softmax(x, axis=-1):
    return torch.softmax(x, dim=axis)
def _gelu(x):
    return torch.nn.functional.gelu(x, approximate="tanh")
def _silu(x):
    return torch.nn.functional.silu(x)
def _sigmoid(x):
    return torch.sigmoid(x)
def _layernorm(x, axis=-1, eps=1e-5):
    m = x.mean(dim=axis, keepdim=True)
    v = x.var(dim=axis, keepdim=True, unbiased=False)
    return (x - m) / torch.sqrt(v + eps)
def _scatter_add(tgt, idx, src, axis=0):
    return tgt.clone().index_add_(axis, idx, src)
def _segment_sum(src, seg, n):
    out = torch.zeros((n,) + src.shape[1:], dtype=src.dtype)
    return out.index_add_(0, seg, src)
def _pad(x, pw):
    flat = tuple(v for pair in reversed(pw) for v in pair)
    return torch.nn.functional.pad(x, flat)

kernel_name = 'standalone__weight_only_int_gptq__prompt'

def setup_inputs():

    _w = (lambda a: (lambda t: t.to(torch.bfloat16) if t.is_floating_point() else t)(torch.as_tensor(a)))
    B, S, D, F = 1, 2048, 1024, 3584
    bits = max(2, min(4, 4))
    pf = 32 // bits
    G = 64 if 64 > 0 else D
    G = max(pf, (G // pf) * pf)
    D = max(G, (D // G) * G)
    ng = D // G
    qmax = 1 << bits
    qw = torch.randint(0, qmax, (D, F)).to(torch.int64)
    packed = torch.zeros((D // pf, F), dtype=torch.int64)
    for i in range(pf):
        packed |= (qw[i::pf] << (i * bits))
    packed = packed.to(torch.int32)
    return {
        "x": _w((lambda *s: torch.randn(*s, dtype=torch.bfloat16) * 0.05)(B, S, D)),
        "qw_packed": _w(packed),
        "scales": _w(torch.abs((lambda *s: torch.randn(*s, dtype=torch.bfloat16) * 0.05)(ng, F)).to(float) * 0.1 + 0.01),
        "zeros": _w(torch.randint(0, qmax, (ng, F)).to(float)),
        "bits": _w((lambda _x: torch.as_tensor(_x, dtype=torch.int32))(bits)),
    }

def reference(x, qw_packed, scales, zeros, bits):
    b = int(bits)
    pf = 32 // b
    mask = (1 << b) - 1
    P, F = qw_packed.shape
    D = P * pf
    ng = scales.shape[0]
    G = D // ng
    shifts = (lambda x, dt: x.to(dt))(torch.arange(pf) * b, qw_packed.dtype)
    qw = ((qw_packed[:, None, :] >> shifts[None, :, None]) & mask).reshape(D, F)
    s = (lambda x, n, axis: torch.repeat_interleave(x, n, dim=axis))(scales, G, axis=0)
    z = (lambda x, n, axis: torch.repeat_interleave(x, n, dim=axis))(zeros, G, axis=0)
    w = ((lambda x, dt: x.to(dt))(qw, x.dtype) - z) * s
    return torch.einsum("bsd,df->bsf", x, w)
```

```asm
; @launch grid=(256,1,1) block=(512,1,1) lds=163840
.amdgcn_target "amdgcn-amd-amdhsa--gfx950"
.text
.globl standalone__weight_only_int_gptq__prompt_kernel
.p2align 12
.type standalone__weight_only_int_gptq__prompt_kernel,@function
standalone__weight_only_int_gptq__prompt_kernel:
  s_load_dwordx2 s[8:9], s[0:1], 0
  s_load_dwordx2 s[12:13], s[0:1], 8
  s_load_dwordx2 s[16:17], s[0:1], 16
  s_load_dwordx2 s[20:21], s[0:1], 24
  s_load_dwordx2 s[24:25], s[0:1], 40
  v_lshrrev_b32 v1, 6, v0
  s_lshr_b32 s35, s2, 3
  s_sub_u32 s36, 62, s35
  v_readfirstlane_b32 s30, v1
  s_bitcmp1_b32 s2, 0
  s_cselect_b32 s34, s36, s35
  s_addc_u32 s35, s35, 0
  s_cmp_gt_u32 s35, 31
  s_cbranch_scc1 DONE
  s_mul_i32 s35, s34, 37
  s_lshr_b32 s35, s35, 8
  s_bfe_u32 s36, s2, 0x20001
  s_sub_u32 s36, s36, s35
  s_mul_i32 s36, s36, 7
  s_add_u32 s31, s34, s36
  s_mul_i32 s32, s35, 224
  s_and_b32 s47, s35, 1
  s_cmp_gt_u32 s35, 4
  s_movk_i32 s41, 2016
  s_cselect_b32 s41, 2032, s41
  s_sub_u32 s41, s41, s32
  s_sub_u32 s36, s35, 2
  s_cmp_ge_u32 s36, 5
  s_cselect_b32 s33, 1, 0
  s_mov_b32 s10, 4194304
  s_mov_b32 s11, 0x00020000
  s_mov_b32 s14, 1835008
  s_mov_b32 s15, 0x00020000
  s_mov_b32 s18, 114688
  s_mov_b32 s19, 0x00020000
  s_mov_b32 s22, 114688
  s_mov_b32 s23, 0x00020000
  s_mov_b32 s26, 14680064
  s_mov_b32 s27, 0x00020000
  s_cmp_lt_u32 s30, 4
  s_cbranch_scc1 LD
  s_setprio 3
  s_sub_u32 s30, s30, 4
  v_and_b32 v1, 15, v0
  v_bfe_u32 v2, v0, 4, 2
  s_lshl_b32 s34, s31, 7
  s_lshl_b32 s35, s30, 4
  s_add_u32 s34, s34, s35
  v_mul_u32_u24 v3, 14336, v2
  v_lshl_add_u32 v3, v1, 2, v3
  v_lshlrev_b32 v4, 1, v1
  v_mov_b64 v[54:55], 0
  v_mov_b64 v[56:57], 0
  v_mov_b64 v[92:93], 0
  v_mov_b64 v[94:95], 0
  v_add_u32 v6, 1720320, v3
  v_add_u32 v7, 107520, v4
  s_lshl_b32 s35, s34, 2
  s_lshl_b32 s34, s47, 8
  s_add_u32 s34, s34, s35
  s_xor_b32 s35, s34, 256
  s_lshr_b32 s36, s34, 1
  s_lshr_b32 s50, s35, 1
  s_add_u32 s48, s34, 57344
  s_add_u32 s49, s35, 57344
  s_and_b32 vcc_lo, s30, 1
  s_mov_b32 vcc_hi, 0
  s_cmp_eq_u32 s33, 1
  s_waitcnt lgkmcnt(0)
  buffer_load_short_d16_hi v92, v7, s[16:19], s36 offen
  buffer_load_short_d16_hi v93, v7, s[16:19], s50 offen
  buffer_load_short_d16_hi v94, v7, s[20:23], s36 offen
  buffer_load_short_d16_hi v95, v7, s[20:23], s50 offen
  buffer_load_dword v88, v6, s[12:15], s34 offen
  buffer_load_dword v89, v6, s[12:15], s35 offen
  buffer_load_dword v90, v6, s[12:15], s48 offen
  buffer_load_dword v91, v6, s[12:15], s49 offen
  buffer_load_short_d16_hi v54, v4, s[16:19], s36 offen
  buffer_load_short_d16_hi v55, v4, s[16:19], s50 offen
  buffer_load_short_d16_hi v56, v4, s[20:23], s36 offen
  buffer_load_short_d16_hi v57, v4, s[20:23], s50 offen
  buffer_load_dword v40, v3, s[12:15], s34 offen
  buffer_load_dword v41, v3, s[12:15], s35 offen
  buffer_load_dword v42, v3, s[12:15], s48 offen
  buffer_load_dword v43, v3, s[12:15], s49 offen
  s_cbranch_vccz CP
  s_cbranch_scc1 CE
  s_cmp_eq_u32 s30, 1
  s_cbranch_scc1 CN
  s_branch TCN
CE:
  s_cmp_eq_u32 s30, 1
  s_cbranch_scc1 CH
  s_branch TCH
DONE:
  s_waitcnt lgkmcnt(0)
  s_endpgm
LD:
  s_setprio 2
  v_and_b32 v0, 63, v0
  v_lshrrev_b32 v1, 3, v0
  v_and_b32 v2, 7, v0
  v_lshrrev_b32 v3, 4, v0
  s_and_b32 s34, s30, 1
  s_lshl_b32 s34, s34, 2
  v_or_b32 v9, s34, v3
  v_xor_b32 v2, v2, v9
  s_lshl_b32 s34, s30, 3
  s_add_u32 s34, s34, s32
  v_add_u32 v1, s34, v1
  v_lshlrev_b32 v1, 11, v1
  v_lshl_add_u32 v1, v2, 4, v1
  v_lshrrev_b32 v4, 5, v0
  v_and_b32 v8, 31, v0
  v_lshlrev_b32 v6, 2, v4
  s_lshl_b32 s34, s47, 4
  v_xor_b32 v8, s34, v8
  v_xor_b32 v8, v8, v6
  s_lshl_b32 s34, s30, 1
  s_add_u32 s34, s34, 8
  v_add_u32 v4, s34, v4
  v_mul_u32_u24 v4, 14336, v4
  v_lshl_add_u32 v4, v8, 4, v4
  s_lshl_b32 s40, s31, 9
  s_lshl_b32 s52, s30, 10
  s_add_u32 s52, s52, 8192
  s_mov_b32 s38, 0
  s_mov_b32 s39, s52
  s_cmp_lt_u32 s30, 2
  s_cselect_b32 s42, s33, 0
  s_lshl_b32 s48, s41, 11
  s_mov_b32 s37, 0
  v_and_b32 v5, 15, v0
  s_lshl_b32 s34, s30, 2
  v_add_u32 v10, s34, v3
  v_mul_u32_u24 v11, 7168, v10
  s_lshl_b32 s34, s47, 3
  v_xor_b32 v15, s34, v5
  v_lshl_add_u32 v15, v15, 4, v11
  s_lshl_b32 s45, s31, 8
  s_add_u32 s56, s52, 69632
  s_movk_i32 s57, 1920
  s_mul_i32 s58, s30, 2
  s_add_u32 s58, s58, 4
  s_mov_b64 vcc, 1
  s_mov_b32 s14, 1720320
  s_waitcnt lgkmcnt(0)
  s_branch LA
LS:
  s_sub_u32 m0, s52, 8192
  s_nop 0
  buffer_load_dwordx4 v15, s[16:19], s45 offen lds
  s_sub_u32 m0, s52, 4096
  s_cmp_eq_u32 s37, 4
  buffer_load_dwordx4 v15, s[20:23], s45 offen lds
LI:
  s_cbranch_scc0 LJ
  s_mov_b32 m0, s56
  s_add_u32 s56, s56, 4096
  buffer_load_dwordx4 v1, s[8:11], s57 offen lds
  s_add_u32 s57, s57, 65536
LJ:
  s_add_u32 m0, s39, 20480
  s_add_u32 s34, s38, 262144
  buffer_load_dwordx4 v1, s[8:11], s34 offen lds
  s_add_u32 m0, s39, 24576
  s_add_u32 s34, s38, 327680
  buffer_load_dwordx4 v1, s[8:11], s34 offen lds
  s_add_u32 m0, s39, 28672
  s_add_u32 s34, s38, 393216
  buffer_load_dwordx4 v1, s[8:11], s34 offen lds
  s_cmp_eq_u32 s42, 0
  s_cbranch_scc1 LX
  s_add_u32 m0, s39, 32768
  s_add_u32 s34, s38, s48
  buffer_load_dwordx4 v1, s[8:11], s34 offen lds
LX:
  s_add_u32 s38, s38, 128
  s_add_u32 s40, s40, 114688
  s_sub_u32 s34, s39, 34816
  s_xor_b32 s34, s34, 86016
  s_add_u32 s39, s39, 34816
  s_bitcmp0_b32 s37, 0
  s_cselect_b32 s39, s34, s39
  s_cmp_eq_u32 s37, 15
  s_cbranch_scc1 LZ
  s_cmp_lg_u32 s37, 2
  s_cbranch_scc1 LA
  s_cmp_lg_u32 s42, 0
  s_waitcnt vmcnt(9)
  s_cbranch_scc1 LB0
  s_waitcnt vmcnt(8)
LB0:
  s_barrier
LA:
  s_add_u32 m0, s39, 4096
  s_add_u32 s34, s38, 0
  buffer_load_dwordx4 v1, s[8:11], s34 offen lds
  s_mov_b32 m0, s39
  s_add_u32 s37, s37, 1
  buffer_load_dwordx4 v4, s[12:15], s40 offen lds
  s_add_u32 m0, s39, 8192
  s_add_u32 s34, s38, 65536
  buffer_load_dwordx4 v1, s[8:11], s34 offen lds
  s_add_u32 m0, s39, 12288
  s_add_u32 s34, s38, 131072
  buffer_load_dwordx4 v1, s[8:11], s34 offen lds
  s_add_u32 m0, s39, 16384
  s_add_u32 s34, s38, 196608
  buffer_load_dwordx4 v1, s[8:11], s34 offen lds
  s_cmp_eq_u32 s37, 1
  s_cbranch_scc1 LS
  s_cmp_le_u32 s37, 3
  s_cbranch_scc1 LJ
  s_cmp_ge_u32 s37, s58
  s_cbranch_scc1 LT
LW:
  s_cmp_lg_u32 s42, 0
  s_waitcnt vmcnt(14)
  s_cbranch_scc1 LB
  s_waitcnt vmcnt(13)
LB:
  s_barrier
  s_setprio 0
  s_lshr_b32 s34, s37, 2
  s_cmp_eq_u32 s34, 1
  s_branch LI
LT:
  s_cmp_eq_u32 s33, 1
  s_cbranch_scc1 LTH
LTN:
  s_cmp_eq_u32 s30, 1
  s_cbranch_scc1 T2N
  s_cmp_eq_u32 s30, 3
  s_cbranch_scc1 T4N
  s_cmp_eq_u32 s30, 0
  s_cbranch_scc0 T3N
  s_cmp_lt_u32 s37, 12
  s_cbranch_scc1 T1N
  s_branch T5N
LTH:
  s_cmp_eq_u32 s30, 1
  s_cbranch_scc1 T2H
  s_cmp_eq_u32 s30, 3
  s_cbranch_scc1 T4H
  s_cmp_eq_u32 s30, 0
  s_cbranch_scc0 T3H
  s_cmp_lt_u32 s37, 12
  s_cbranch_scc1 T1H
  s_branch T5H
LZ:
  s_add_u32 m0, s39, 0
  s_add_u32 s34, s38, 262144
  buffer_load_dwordx4 v1, s[8:11], s34 offen lds
  s_add_u32 m0, s39, 4096
  s_add_u32 s34, s38, 327680
  buffer_load_dwordx4 v1, s[8:11], s34 offen lds
  s_add_u32 m0, s39, 8192
  s_add_u32 s34, s38, 393216
  buffer_load_dwordx4 v1, s[8:11], s34 offen lds
  s_cmp_eq_u32 s42, 0
  s_cbranch_scc1 LY
  s_add_u32 m0, s39, 12288
  s_add_u32 s34, s38, s48
  buffer_load_dwordx4 v1, s[8:11], s34 offen lds
  s_waitcnt vmcnt(8)
  s_branch LY2
LY:
  s_waitcnt vmcnt(6)
LY2:
  s_barrier
  v_lshrrev_b32 v13, 3, v5
  v_and_b32 v14, 7, v5
  v_lshl_or_b32 v14, v14, 1, v13
  v_xor_b32 v14, v14, v10
  v_lshlrev_b32 v13, 11, v13
  v_lshl_add_u32 v13, v10, 7, v13
  v_lshl_add_u32 v13, v14, 3, v13
  v_xor_b32 v14, 8, v13
  s_mul_i32 s38, s32, 7168
  s_add_u32 s38, s38, s45
  s_mul_i32 s48, s41, 7168
  s_add_u32 s48, s48, s38
  s_mov_b32 s59, 110592
  s_mov_b32 s37, 0
  s_setprio 3
  s_waitcnt vmcnt(0)
SA:
  s_barrier
  ds_read_b64 v[24:25], v13 offset:0
  ds_read_b64 v[26:27], v14 offset:0
  ds_read_b64 v[28:29], v13 offset:4096
  ds_read_b64 v[30:31], v14 offset:4096
  s_cmp_eq_u32 s37, 4
  s_cselect_b32 s58, s59, 0x2000
  s_add_u32 s37, s37, 1
  v_add_u32 v13, s58, v13
  v_add_u32 v14, s58, v14
  s_waitcnt lgkmcnt(2)
  buffer_store_dwordx4 v[24:27], v15, s[24:27], s38 offen sc0 sc1
  s_add_u32 s38, s38, 114688
  s_waitcnt lgkmcnt(0)
  buffer_store_dwordx4 v[28:31], v15, s[24:27], s38 offen sc0 sc1
  s_add_u32 s38, s38, 114688
  s_cmp_lt_u32 s37, 6
  s_cbranch_scc1 SA
  s_barrier
  ds_read_b64 v[24:25], v13 offset:0
  ds_read_b64 v[26:27], v14 offset:0
  ds_read_b64 v[28:29], v13 offset:4096
  ds_read_b64 v[30:31], v14 offset:4096
  ds_read_b64 v[32:33], v13 offset:8192
  ds_read_b64 v[34:35], v14 offset:8192
  s_waitcnt lgkmcnt(4)
  buffer_store_dwordx4 v[24:27], v15, s[24:27], s38 offen sc0 sc1
  s_add_u32 s38, s38, 114688
  s_cmp_eq_u32 s33, 0
  s_waitcnt lgkmcnt(2)
  buffer_store_dwordx4 v[28:31], v15, s[24:27], s38 offen sc0 sc1
  s_cbranch_scc1 SEND
  s_mov_b32 exec_lo, 0x00ff00ff
  s_mov_b32 exec_hi, 0x00ff00ff
  s_waitcnt lgkmcnt(0)
  buffer_store_dwordx4 v[32:35], v15, s[24:27], s48 offen sc0 sc1
SEND:
  s_waitcnt lgkmcnt(0)
  s_endpgm
.p2align 6
CP:
  s_mov_b32 vcc_lo, 0
  s_lshl_b32 s36, s30, 5
  v_add_u32 v81, s36, v4
  s_mov_b32 s54, 0x4b800000
  s_mov_b32 s55, 0x49800000
  s_mov_b32 s28, 0x000f000f
  s_mov_b32 s29, 0x00f000f0
  v_lshrrev_b32 v5, 1, v1
  v_xor_b32 v5, v5, v2
  v_lshlrev_b32 v5, 4, v5
  v_lshl_add_u32 v5, v1, 7, v5
  v_add_u32 v78, 12288, v5
  v_xor_b32 v79, 64, v78
  v_add_u32 v82, 77824, v5
  v_xor_b32 v87, 64, v82
  s_mov_b32 s43, 110592
  s_mov_b32 s44, 86016
  s_movk_i32 s45, 512
  s_lshl_b32 s35, s30, 6
  v_lshl_add_u32 v5, v1, 2, s35
  v_and_b32 v3, 1, v2
  v_lshlrev_b32 v3, 6, v3
  v_xor_b32 v5, v5, v3
  v_lshl_add_u32 v5, v2, 9, v5
  v_add_u32 v80, 8192, v5
  s_lshl_b32 s36, s30, 2
  v_or_b32 v3, s36, v2
  v_xor_b32 v3, v3, v1
  v_lshlrev_b32 v3, 3, v3
  v_lshl_add_u32 v83, v1, 7, v3
  v_xor_b32 v86, 8, v83
  v_add_u32 v58, 143360, v83
  v_xor_b32 v59, 8, v58
  v_mov_b64 v[136:137], 0
  v_mov_b64 v[138:139], 0
  v_mov_b64 v[140:141], 0
  v_mov_b64 v[142:143], 0
  v_mov_b64 v[144:145], 0
  v_mov_b64 v[146:147], 0
  v_mov_b64 v[148:149], 0
  v_mov_b64 v[150:151], 0
  v_mov_b64 v[152:153], 0
  v_mov_b64 v[154:155], 0
  v_mov_b64 v[156:157], 0
  v_mov_b64 v[158:159], 0
  v_mov_b64 v[160:161], 0
  v_mov_b64 v[162:163], 0
  v_mov_b64 v[164:165], 0
  v_mov_b64 v[166:167], 0
  v_mov_b64 v[168:169], 0
  v_mov_b64 v[170:171], 0
  v_mov_b64 v[172:173], 0
  v_mov_b64 v[174:175], 0
  v_mov_b64 v[176:177], 0
  v_mov_b64 v[178:179], 0
  v_mov_b64 v[180:181], 0
  v_mov_b64 v[182:183], 0
  v_mov_b64 v[184:185], 0
  v_mov_b64 v[186:187], 0
  v_mov_b64 v[188:189], 0
  v_mov_b64 v[190:191], 0
  v_mov_b64 v[192:193], 0
  v_mov_b64 v[194:195], 0
  v_mov_b64 v[196:197], 0
  v_mov_b64 v[198:199], 0
  v_mov_b64 v[200:201], 0
  v_mov_b64 v[202:203], 0
  v_mov_b64 v[204:205], 0
  v_mov_b64 v[206:207], 0
  v_mov_b64 v[208:209], 0
  v_mov_b64 v[210:211], 0
  v_mov_b64 v[212:213], 0
  v_mov_b64 v[214:215], 0
  v_mov_b64 v[216:217], 0
  v_mov_b64 v[218:219], 0
  v_mov_b64 v[220:221], 0
  v_mov_b64 v[222:223], 0
  v_mov_b64 v[224:225], 0
  v_mov_b64 v[226:227], 0
  v_mov_b64 v[228:229], 0
  v_mov_b64 v[230:231], 0
  v_mov_b64 v[232:233], 0
  v_mov_b64 v[234:235], 0
  v_mov_b64 v[236:237], 0
  v_mov_b64 v[238:239], 0
  v_mov_b64 v[240:241], 0
  v_mov_b64 v[242:243], 0
  v_mov_b64 v[244:245], 0
  v_mov_b64 v[246:247], 0
  s_mov_b32 s37, 6
  s_waitcnt vmcnt(12)
  v_mul_f32 v48, s54, v92
  v_mul_f32 v52, -v94, v92
  v_mul_f32 v50, s55, v92
  v_mul_f32 v49, s54, v93
  v_mul_f32 v53, -v95, v93
  v_mul_f32 v51, s55, v93
  s_waitcnt vmcnt(11)
  v_and_b32 v60, s28, v88
  v_and_b32 v61, s29, v88
  v_lshrrev_b32 v64, 8, v88
  v_fma_mix_f32 v65, v60, v48, v52 op_sel_hi:[1,0,0]
  v_fma_mix_f32 v66, v61, v50, v52 op_sel_hi:[1,0,0]
  v_and_b32 v62, s28, v64
  v_and_b32 v63, s29, v64
  v_fma_mix_f32 v67, v60, v48, v52 op_sel:[1,0,0] op_sel_hi:[1,0,0]
  v_fma_mix_f32 v68, v61, v50, v52 op_sel:[1,0,0] op_sel_hi:[1,0,0]
  v_cvt_pk_bf16_f32 v0, v65, v66
  v_fma_mix_f32 v65, v62, v48, v52 op_sel_hi:[1,0,0]
  v_fma_mix_f32 v66, v63, v50, v52 op_sel_hi:[1,0,0]
  v_cvt_pk_bf16_f32 v2, v67, v68
  v_fma_mix_f32 v67, v62, v48, v52 op_sel:[1,0,0] op_sel_hi:[1,0,0]
  v_fma_mix_f32 v68, v63, v50, v52 op_sel:[1,0,0] op_sel_hi:[1,0,0]
  v_cvt_pk_bf16_f32 v1, v65, v66
  v_cvt_pk_bf16_f32 v3, v67, v68
  s_waitcnt vmcnt(10)
  v_and_b32 v69, s28, v89
  v_and_b32 v70, s29, v89
  v_lshrrev_b32 v73, 8, v89
  v_fma_mix_f32 v74, v69, v49, v53 op_sel_hi:[1,0,0]
  v_fma_mix_f32 v75, v70, v51, v53 op_sel_hi:[1,0,0]
  v_and_b32 v71, s28, v73
  v_and_b32 v72, s29, v73
  v_fma_mix_f32 v76, v69, v49, v53 op_sel:[1,0,0] op_sel_hi:[1,0,0]
  v_fma_mix_f32 v77, v70, v51, v53 op_sel:[1,0,0] op_sel_hi:[1,0,0]
  v_cvt_pk_bf16_f32 v4, v74, v75
  v_fma_mix_f32 v74, v71, v49, v53 op_sel_hi:[1,0,0]
  v_fma_mix_f32 v75, v72, v51, v53 op_sel_hi:[1,0,0]
  v_cvt_pk_bf16_f32 v6, v76, v77
  v_fma_mix_f32 v76, v71, v49, v53 op_sel:[1,0,0] op_sel_hi:[1,0,0]
  v_fma_mix_f32 v77, v72, v51, v53 op_sel:[1,0,0] op_sel_hi:[1,0,0]
  v_cvt_pk_bf16_f32 v5, v74, v75
  v_cvt_pk_bf16_f32 v7, v76, v77
  s_waitcnt vmcnt(9)
  v_and_b32 v60, s28, v90
  v_and_b32 v61, s29, v90
  v_lshrrev_b32 v64, 8, v90
  v_fma_mix_f32 v65, v60, v48, v52 op_sel_hi:[1,0,0]
  v_fma_mix_f32 v66, v61, v50, v52 op_sel_hi:[1,0,0]
  v_and_b32 v62, s28, v64
  v_and_b32 v63, s29, v64
  v_fma_mix_f32 v67, v60, v48, v52 op_sel:[1,0,0] op_sel_hi:[1,0,0]
  v_fma_mix_f32 v68, v61, v50, v52 op_sel:[1,0,0] op_sel_hi:[1,0,0]
  v_cvt_pk_bf16_f32 v128, v65, v66
  v_fma_mix_f32 v65, v62, v48, v52 op_sel_hi:[1,0,0]
  v_fma_mix_f32 v66, v63, v50, v52 op_sel_hi:[1,0,0]
  v_cvt_pk_bf16_f32 v130, v67, v68
  v_fma_mix_f32 v67, v62, v48, v52 op_sel:[1,0,0] op_sel_hi:[1,0,0]
  v_fma_mix_f32 v68, v63, v50, v52 op_sel:[1,0,0] op_sel_hi:[1,0,0]
  v_cvt_pk_bf16_f32 v129, v65, v66
  v_cvt_pk_bf16_f32 v131, v67, v68
  s_waitcnt vmcnt(8)
  v_and_b32 v69, s28, v91
  v_and_b32 v70, s29, v91
  v_lshrrev_b32 v73, 8, v91
  v_fma_mix_f32 v74, v69, v49, v53 op_sel_hi:[1,0,0]
  v_fma_mix_f32 v75, v70, v51, v53 op_sel_hi:[1,0,0]
  v_and_b32 v71, s28, v73
  v_and_b32 v72, s29, v73
  v_fma_mix_f32 v76, v69, v49, v53 op_sel:[1,0,0] op_sel_hi:[1,0,0]
  v_fma_mix_f32 v77, v70, v51, v53 op_sel:[1,0,0] op_sel_hi:[1,0,0]
  v_cvt_pk_bf16_f32 v132, v74, v75
  v_fma_mix_f32 v74, v71, v49, v53 op_sel_hi:[1,0,0]
  v_fma_mix_f32 v75, v72, v51, v53 op_sel_hi:[1,0,0]
  v_cvt_pk_bf16_f32 v134, v76, v77
  v_fma_mix_f32 v76, v71, v49, v53 op_sel:[1,0,0] op_sel_hi:[1,0,0]
  v_fma_mix_f32 v77, v72, v51, v53 op_sel:[1,0,0] op_sel_hi:[1,0,0]
  v_cvt_pk_bf16_f32 v133, v74, v75
  v_cvt_pk_bf16_f32 v135, v76, v77
  s_cmp_eq_u32 s33, 1
  s_waitcnt vmcnt(4)
  s_cbranch_scc1 CH
  s_branch CN
.p2align 12
CH:
  s_cbranch_vccnz CP
  v_mov_b64 v[248:249], 0
  v_mov_b64 v[250:251], 0
  v_mul_f32 v48, s54, v54
  v_mul_f32 v52, -v56, v54
  v_mul_f32 v50, s55, v54
  v_mul_f32 v49, s54, v55
  v_mul_f32 v53, -v57, v55
  v_mul_f32 v51, s55, v55
  s_waitcnt vmcnt(3)
  v_and_b32 v60, s28, v40
  v_and_b32 v61, s29, v40
  v_lshrrev_b32 v64, 8, v40
  v_fma_mix_f32 v65, v60, v48, v52 op_sel_hi:[1,0,0]
  v_fma_mix_f32 v66, v61, v50, v52 op_sel_hi:[1,0,0]
  v_and_b32 v62, s28, v64
  v_and_b32 v63, s29, v64
  v_fma_mix_f32 v67, v60, v48, v52 op_sel:[1,0,0] op_sel_hi:[1,0,0]
  v_fma_mix_f32 v68, v61, v50, v52 op_sel:[1,0,0] op_sel_hi:[1,0,0]
  v_cvt_pk_bf16_f32 v8, v65, v66
  v_fma_mix_f32 v65, v62, v48, v52 op_sel_hi:[1,0,0]
  v_fma_mix_f32 v66, v63, v50, v52 op_sel_hi:[1,0,0]
  v_cvt_pk_bf16_f32 v10, v67, v68
  v_fma_mix_f32 v67, v62, v48, v52 op_sel:[1,0,0] op_sel_hi:[1,0,0]
  v_fma_mix_f32 v68, v63, v50, v52 op_sel:[1,0,0] op_sel_hi:[1,0,0]
  v_cvt_pk_bf16_f32 v9, v65, v66
  v_cvt_pk_bf16_f32 v11, v67, v68
  s_waitcnt vmcnt(2)
  v_and_b32 v69, s28, v41
  v_and_b32 v70, s29, v41
  v_lshrrev_b32 v73, 8, v41
  v_fma_mix_f32 v74, v69, v49, v53 op_sel_hi:[1,0,0]
  v_fma_mix_f32 v75, v70, v51, v53 op_sel_hi:[1,0,0]
  v_and_b32 v71, s28, v73
  v_and_b32 v72, s29, v73
  v_fma_mix_f32 v76, v69, v49, v53 op_sel:[1,0,0] op_sel_hi:[1,0,0]
  v_fma_mix_f32 v77, v70, v51, v53 op_sel:[1,0,0] op_sel_hi:[1,0,0]
  v_cvt_pk_bf16_f32 v12, v74, v75
  v_fma_mix_f32 v74, v71, v49, v53 op_sel_hi:[1,0,0]
  v_fma_mix_f32 v75, v72, v51, v53 op_sel_hi:[1,0,0]
  v_cvt_pk_bf16_f32 v14, v76, v77
  v_fma_mix_f32 v76, v71, v49, v53 op_sel:[1,0,0] op_sel_hi:[1,0,0]
  v_fma_mix_f32 v77, v72, v51, v53 op_sel:[1,0,0] op_sel_hi:[1,0,0]
  v_cvt_pk_bf16_f32 v13, v74, v75
  v_cvt_pk_bf16_f32 v15, v76, v77
  s_waitcnt vmcnt(1)
  v_and_b32 v60, s28, v42
  v_and_b32 v61, s29, v42
  v_lshrrev_b32 v64, 8, v42
  v_fma_mix_f32 v65, v60, v48, v52 op_sel_hi:[1,0,0]
  v_fma_mix_f32 v66, v61, v50, v52 op_sel_hi:[1,0,0]
  v_and_b32 v62, s28, v64
  v_and_b32 v63, s29, v64
  v_fma_mix_f32 v67, v60, v48, v52 op_sel:[1,0,0] op_sel_hi:[1,0,0]
  v_fma_mix_f32 v68, v61, v50, v52 op_sel:[1,0,0] op_sel_hi:[1,0,0]
  v_cvt_pk_bf16_f32 v16, v65, v66
  s_waitcnt vmcnt(0)
  s_setprio 2
  s_barrier
  ds_read_b128 v[88:91], v78 offset:0
  v_fma_mix_f32 v65, v62, v48, v52 op_sel_hi:[1,0,0]
  v_fma_mix_f32 v66, v63, v50, v52 op_sel_hi:[1,0,0]
  ds_read_u16_d16_hi v54, v81 offset:256
  v_cvt_pk_bf16_f32 v18, v67, v68
  v_fma_mix_f32 v67, v62, v48, v52 op_sel:[1,0,0] op_sel_hi:[1,0,0]
  ds_read_u16_d16_hi v55, v81 offset:384
  v_fma_mix_f32 v68, v63, v50, v52 op_sel:[1,0,0] op_sel_hi:[1,0,0]
  v_cvt_pk_bf16_f32 v17, v65, v66
  ds_read_u16_d16_hi v56, v81 offset:4352
  v_cvt_pk_bf16_f32 v19, v67, v68
  v_and_b32 v69, s28, v43
  ds_read_u16_d16_hi v57, v81 offset:4480
  v_and_b32 v70, s29, v43
  v_lshrrev_b32 v73, 8, v43
  ds_read2st64_b32 v[44:45], v80 offset0:0 offset1:1
  v_fma_mix_f32 v74, v69, v49, v53 op_sel_hi:[1,0,0]
  v_fma_mix_f32 v75, v70, v51, v53 op_sel_hi:[1,0,0]
  ds_read_b128 v[92:95], v78 offset:2048
  v_and_b32 v71, s28, v73
  v_and_b32 v72, s29, v73
  ds_read2st64_b32 v[46:47], v80 offset0:8 offset1:9
  v_fma_mix_f32 v76, v69, v49, v53 op_sel:[1,0,0] op_sel_hi:[1,0,0]
  v_fma_mix_f32 v77, v70, v51, v53 op_sel:[1,0,0] op_sel_hi:[1,0,0]
  ds_read_b128 v[96:99], v78 offset:4096
  v_cvt_pk_bf16_f32 v20, v74, v75
  v_fma_mix_f32 v74, v71, v49, v53 op_sel_hi:[1,0,0]
  ds_read_b128 v[100:103], v78 offset:6144
  v_fma_mix_f32 v75, v72, v51, v53 op_sel_hi:[1,0,0]
  v_cvt_pk_bf16_f32 v22, v76, v77
  ds_read_b128 v[104:107], v78 offset:8192
  v_fma_mix_f32 v76, v71, v49, v53 op_sel:[1,0,0] op_sel_hi:[1,0,0]
  v_fma_mix_f32 v77, v72, v51, v53 op_sel:[1,0,0] op_sel_hi:[1,0,0]
  ds_read_b128 v[108:111], v78 offset:10240
  v_cvt_pk_bf16_f32 v21, v74, v75
  v_cvt_pk_bf16_f32 v23, v76, v77
  s_waitcnt lgkmcnt(7)
  s_nop 0
.p2align 3
CLH:
  v_mfma_f32_16x16x32_bf16 v[136:139], v[8:11], v[88:91], v[136:139]
  ds_read_b128 v[112:115], v78 offset:12288
  v_mul_f32 v48, s54, v54
  v_mfma_f32_16x16x32_bf16 v[140:143], v[12:15], v[88:91], v[140:143]
  s_waitcnt lgkmcnt(6)
  v_mul_f32 v52, -v56, v54
  v_add_u32 v81, s45, v81
  v_mfma_f32_16x16x32_bf16 v[148:151], v[12:15], v[92:95], v[148:151]
  ds_read_b128 v[116:119], v78 offset:14336
  v_mul_f32 v50, s55, v54
  v_mfma_f32_16x16x32_bf16 v[144:147], v[8:11], v[92:95], v[144:147]
  s_waitcnt lgkmcnt(5)
  v_mul_f32 v49, s54, v55
  v_mul_f32 v53, -v57, v55
  v_mfma_f32_16x16x32_bf16 v[152:155], v[8:11], v[96:99], v[152:155]
  ds_read_b128 v[120:123], v78 offset:16384
  v_mul_f32 v51, s55, v55
  v_mfma_f32_16x16x32_bf16 v[156:159], v[12:15], v[96:99], v[156:159]
  s_waitcnt lgkmcnt(5)
  v_and_b32 v60, s28, v44
  v_and_b32 v61, s29, v44
  v_mfma_f32_16x16x32_bf16 v[164:167], v[12:15], v[100:103], v[164:167]
  ds_read_b128 v[124:127], v78 offset:18432
  v_lshrrev_b32 v64, 8, v44
  v_mfma_f32_16x16x32_bf16 v[160:163], v[8:11], v[100:103], v[160:163]
  s_waitcnt lgkmcnt(5)
  v_fma_mix_f32 v65, v60, v48, v52 op_sel_hi:[1,0,0]
  v_fma_mix_f32 v66, v61, v50, v52 op_sel_hi:[1,0,0]
  v_mfma_f32_16x16x32_bf16 v[168:171], v[8:11], v[104:107], v[168:171]
  ds_read_b128 v[88:91], v78 offset:20480
  v_and_b32 v62, s28, v64
  v_mfma_f32_16x16x32_bf16 v[172:175], v[12:15], v[104:107], v[172:175]
  s_waitcnt lgkmcnt(5)
  ds_read_u16_d16_hi v54, v81 offset:0
  v_and_b32 v63, s29, v64
  v_mfma_f32_16x16x32_bf16 v[180:183], v[12:15], v[108:111], v[180:183]
  ds_read_b128 v[92:95], v78 offset:22528
  v_fma_mix_f32 v67, v60, v48, v52 op_sel:[1,0,0] op_sel_hi:[1,0,0]
  v_mfma_f32_16x16x32_bf16 v[176:179], v[8:11], v[108:111], v[176:179]
  s_waitcnt lgkmcnt(6)
  v_fma_mix_f32 v68, v61, v50, v52 op_sel:[1,0,0] op_sel_hi:[1,0,0]
  v_cvt_pk_bf16_f32 v24, v65, v66
  v_mfma_f32_16x16x32_bf16 v[184:187], v[8:11], v[112:115], v[184:187]
  ds_read_b128 v[96:99], v78 offset:24576
  v_fma_mix_f32 v65, v62, v48, v52 op_sel_hi:[1,0,0]
  v_mfma_f32_16x16x32_bf16 v[188:191], v[12:15], v[112:115], v[188:191]
  s_waitcnt lgkmcnt(6)
  v_fma_mix_f32 v66, v63, v50, v52 op_sel_hi:[1,0,0]
  v_cvt_pk_bf16_f32 v26, v67, v68
  v_mfma_f32_16x16x32_bf16 v[196:199], v[12:15], v[116:119], v[196:199]
  ds_read_b128 v[100:103], v78 offset:26624
  v_mfma_f32_16x16x32_bf16 v[192:195], v[8:11], v[116:119], v[192:195]
  s_waitcnt lgkmcnt(6)
  v_fma_mix_f32 v67, v62, v48, v52 op_sel:[1,0,0] op_sel_hi:[1,0,0]
  v_fma_mix_f32 v68, v63, v50, v52 op_sel:[1,0,0] op_sel_hi:[1,0,0]
  v_mfma_f32_16x16x32_bf16 v[200:203], v[8:11], v[120:123], v[200:203]
  ds_read_b128 v[104:107], v78 offset:28672
  v_cvt_pk_bf16_f32 v25, v65, v66
  v_mfma_f32_16x16x32_bf16 v[204:207], v[12:15], v[120:123], v[204:207]
  s_waitcnt lgkmcnt(6)
  ds_read_u16_d16_hi v55, v81 offset:128
  v_cvt_pk_bf16_f32 v27, v67, v68
  v_mfma_f32_16x16x32_bf16 v[212:215], v[12:15], v[124:127], v[212:215]
  ds_read_b128 v[108:111], v79 offset:0
  v_and_b32 v69, s28, v45
  v_mfma_f32_16x16x32_bf16 v[208:211], v[8:11], v[124:127], v[208:211]
  s_waitcnt lgkmcnt(7)
  v_and_b32 v70, s29, v45
  v_lshrrev_b32 v73, 8, v45
  v_mfma_f32_16x16x32_bf16 v[216:219], v[8:11], v[88:91], v[216:219]
  ds_read_b128 v[112:115], v79 offset:2048
  v_fma_mix_f32 v74, v69, v49, v53 op_sel_hi:[1,0,0]
  v_mfma_f32_16x16x32_bf16 v[220:223], v[12:15], v[88:91], v[220:223]
  s_waitcnt lgkmcnt(6)
  v_fma_mix_f32 v75, v70, v51, v53 op_sel_hi:[1,0,0]
  v_and_b32 v71, s28, v73
  v_mfma_f32_16x16x32_bf16 v[228:231], v[12:15], v[92:95], v[228:231]
  ds_read_b128 v[116:119], v79 offset:4096
  v_and_b32 v72, s29, v73
  v_mfma_f32_16x16x32_bf16 v[224:227], v[8:11], v[92:95], v[224:227]
  s_waitcnt lgkmcnt(6)
  ds_read_u16_d16_hi v56, v81 offset:4096
  v_fma_mix_f32 v76, v69, v49, v53 op_sel:[1,0,0] op_sel_hi:[1,0,0]
  v_mfma_f32_16x16x32_bf16 v[232:235], v[8:11], v[96:99], v[232:235]
  ds_read_b128 v[120:123], v79 offset:6144
  v_fma_mix_f32 v77, v70, v51, v53 op_sel:[1,0,0] op_sel_hi:[1,0,0]
  v_mfma_f32_16x16x32_bf16 v[236:239], v[12:15], v[96:99], v[236:239]
  s_waitcnt lgkmcnt(7)
  v_cvt_pk_bf16_f32 v28, v74, v75
  v_fma_mix_f32 v74, v71, v49, v53 op_sel_hi:[1,0,0]
  v_mfma_f32_16x16x32_bf16 v[244:247], v[12:15], v[100:103], v[244:247]
  ds_read_b128 v[124:127], v79 offset:8192
  v_fma_mix_f32 v75, v72, v51, v53 op_sel_hi:[1,0,0]
  v_mfma_f32_16x16x32_bf16 v[240:243], v[8:11], v[100:103], v[240:243]
  s_waitcnt lgkmcnt(7)
  v_cvt_pk_bf16_f32 v30, v76, v77
  v_fma_mix_f32 v76, v71, v49, v53 op_sel:[1,0,0] op_sel_hi:[1,0,0]
  v_mfma_f32_16x16x32_bf16 v[248:251], v[8:11], v[104:107], v[248:251]
  s_waitcnt lgkmcnt(5)
  ds_read_b128 v[88:91], v79 offset:10240
  v_mfma_f32_16x16x32_bf16 v[136:139], v[16:19], v[108:111], v[136:139]
  ds_read_b128 v[92:95], v79 offset:12288
  v_fma_mix_f32 v77, v72, v51, v53 op_sel:[1,0,0] op_sel_hi:[1,0,0]
  v_mfma_f32_16x16x32_bf16 v[140:143], v[20:23], v[108:111], v[140:143]
  s_waitcnt lgkmcnt(6)
  ds_read_u16_d16_hi v57, v81 offset:4224
  v_cvt_pk_bf16_f32 v29, v74, v75
  v_mfma_f32_16x16x32_bf16 v[148:151], v[20:23], v[112:115], v[148:151]
  ds_read_b128 v[96:99], v79 offset:14336
  v_cvt_pk_bf16_f32 v31, v76, v77
  v_mfma_f32_16x16x32_bf16 v[144:147], v[16:19], v[112:115], v[144:147]
  s_waitcnt lgkmcnt(7)
  v_and_b32 v60, s28, v46
  v_and_b32 v61, s29, v46
  v_mfma_f32_16x16x32_bf16 v[152:155], v[16:19], v[116:119], v[152:155]
  ds_read_b128 v[100:103], v79 offset:16384
  v_lshrrev_b32 v64, 8, v46
  v_mfma_f32_16x16x32_bf16 v[156:159], v[20:23], v[116:119], v[156:159]
  s_waitcnt lgkmcnt(6)
  v_fma_mix_f32 v65, v60, v48, v52 op_sel_hi:[1,0,0]
  v_fma_mix_f32 v66, v61, v50, v52 op_sel_hi:[1,0,0]
  v_mfma_f32_16x16x32_bf16 v[164:167], v[20:23], v[120:123], v[164:167]
  ds_read_b128 v[104:107], v79 offset:18432
  v_and_b32 v62, s28, v64
  v_mfma_f32_16x16x32_bf16 v[160:163], v[16:19], v[120:123], v[160:163]
  s_waitcnt lgkmcnt(6)
  v_and_b32 v63, s29, v64
  v_fma_mix_f32 v67, v60, v48, v52 op_sel:[1,0,0] op_sel_hi:[1,0,0]
  v_mfma_f32_16x16x32_bf16 v[168:171], v[16:19], v[124:127], v[168:171]
  ds_read_b128 v[108:111], v79 offset:20480
  v_fma_mix_f32 v68, v61, v50, v52 op_sel:[1,0,0] op_sel_hi:[1,0,0]
  v_mfma_f32_16x16x32_bf16 v[172:175], v[20:23], v[124:127], v[172:175]
  s_waitcnt lgkmcnt(6)
  v_cvt_pk_bf16_f32 v32, v65, v66
  v_fma_mix_f32 v65, v62, v48, v52 op_sel_hi:[1,0,0]
  v_mfma_f32_16x16x32_bf16 v[180:183], v[20:23], v[88:91], v[180:183]
  ds_read_b128 v[112:115], v79 offset:22528
  v_fma_mix_f32 v66, v63, v50, v52 op_sel_hi:[1,0,0]
  v_mfma_f32_16x16x32_bf16 v[176:179], v[16:19], v[88:91], v[176:179]
  s_waitcnt lgkmcnt(6)
  v_cvt_pk_bf16_f32 v34, v67, v68
  v_fma_mix_f32 v67, v62, v48, v52 op_sel:[1,0,0] op_sel_hi:[1,0,0]
  v_mfma_f32_16x16x32_bf16 v[184:187], v[16:19], v[92:95], v[184:187]
  ds_read_b128 v[116:119], v79 offset:24576
  v_fma_mix_f32 v68, v63, v50, v52 op_sel:[1,0,0] op_sel_hi:[1,0,0]
  v_mfma_f32_16x16x32_bf16 v[188:191], v[20:23], v[92:95], v[188:191]
  s_waitcnt lgkmcnt(5)
  v_cvt_pk_bf16_f32 v33, v65, v66
  v_mfma_f32_16x16x32_bf16 v[196:199], v[20:23], v[96:99], v[196:199]
  ds_read_b128 v[120:123], v79 offset:26624
  v_cvt_pk_bf16_f32 v35, v67, v68
  v_mfma_f32_16x16x32_bf16 v[192:195], v[16:19], v[96:99], v[192:195]
  s_waitcnt lgkmcnt(5)
  v_and_b32 v69, s28, v47
  v_and_b32 v70, s29, v47
  v_mfma_f32_16x16x32_bf16 v[200:203], v[16:19], v[100:103], v[200:203]
  ds_read_b128 v[124:127], v79 offset:28672
  v_lshrrev_b32 v73, 8, v47
  v_mfma_f32_16x16x32_bf16 v[204:207], v[20:23], v[100:103], v[204:207]
  s_waitcnt lgkmcnt(5)
  v_fma_mix_f32 v74, v69, v49, v53 op_sel_hi:[1,0,0]
  v_fma_mix_f32 v75, v70, v51, v53 op_sel_hi:[1,0,0]
  v_mfma_f32_16x16x32_bf16 v[212:215], v[20:23], v[104:107], v[212:215]
  s_barrier
  ds_read_b128 v[88:91], v78 offset:34816
  v_and_b32 v71, s28, v73
  v_mfma_f32_16x16x32_bf16 v[208:211], v[16:19], v[104:107], v[208:211]
  s_waitcnt lgkmcnt(5)
  ds_read2st64_b32 v[40:41], v80 offset0:136 offset1:137
  v_and_b32 v72, s29, v73
  v_mfma_f32_16x16x32_bf16 v[216:219], v[16:19], v[108:111], v[216:219]
  ds_read_b128 v[92:95], v78 offset:36864
  v_fma_mix_f32 v76, v69, v49, v53 op_sel:[1,0,0] op_sel_hi:[1,0,0]
  v_mfma_f32_16x16x32_bf16 v[220:223], v[20:23], v[108:111], v[220:223]
  s_waitcnt lgkmcnt(6)
  ds_read2st64_b32 v[42:43], v80 offset0:144 offset1:145
  v_fma_mix_f32 v77, v70, v51, v53 op_sel:[1,0,0] op_sel_hi:[1,0,0]
  v_mfma_f32_16x16x32_bf16 v[228:231], v[20:23], v[112:115], v[228:231]
  ds_read_b128 v[96:99], v78 offset:38912
  v_cvt_pk_bf16_f32 v36, v74, v75
  v_mfma_f32_16x16x32_bf16 v[224:227], v[16:19], v[112:115], v[224:227]
  s_waitcnt lgkmcnt(7)
  v_fma_mix_f32 v74, v71, v49, v53 op_sel_hi:[1,0,0]
  v_fma_mix_f32 v75, v72, v51, v53 op_sel_hi:[1,0,0]
  v_mfma_f32_16x16x32_bf16 v[232:235], v[16:19], v[116:119], v[232:235]
  s_sub_u32 s37, s37, 1
  ds_read_b128 v[100:103], v78 offset:40960
  v_cvt_pk_bf16_f32 v38, v76, v77
  v_mfma_f32_16x16x32_bf16 v[236:239], v[20:23], v[116:119], v[236:239]
  s_waitcnt lgkmcnt(7)
  v_fma_mix_f32 v76, v71, v49, v53 op_sel:[1,0,0] op_sel_hi:[1,0,0]
  v_fma_mix_f32 v77, v72, v51, v53 op_sel:[1,0,0] op_sel_hi:[1,0,0]
  v_mfma_f32_16x16x32_bf16 v[244:247], v[20:23], v[120:123], v[244:247]
  ds_read_b128 v[104:107], v78 offset:43008
  v_cvt_pk_bf16_f32 v37, v74, v75
  v_mfma_f32_16x16x32_bf16 v[240:243], v[16:19], v[120:123], v[240:243]
  s_waitcnt lgkmcnt(6)
  v_cvt_pk_bf16_f32 v39, v76, v77
  v_mfma_f32_16x16x32_bf16 v[248:251], v[16:19], v[124:127], v[248:251]
  ds_read_b128 v[108:111], v78 offset:45056
  v_xor_b32 v80, s44, v80
  s_cbranch_scc1 FAH
  v_mfma_f32_16x16x32_bf16 v[136:139], v[24:27], v[88:91], v[136:139]
  ds_read_b128 v[112:115], v78 offset:47104
  v_mul_f32 v48, s54, v54
  v_mfma_f32_16x16x32_bf16 v[140:143], v[28:31], v[88:91], v[140:143]
  s_waitcnt lgkmcnt(6)
  v_mul_f32 v52, -v56, v54
  v_mul_f32 v50, s55, v54
  v_mfma_f32_16x16x32_bf16 v[148:151], v[28:31], v[92:95], v[148:151]
  ds_read_b128 v[116:119], v78 offset:49152
  v_mul_f32 v49, s54, v55
  v_mfma_f32_16x16x32_bf16 v[144:147], v[24:27], v[92:95], v[144:147]
  s_waitcnt lgkmcnt(5)
  v_mul_f32 v53, -v57, v55
  v_mul_f32 v51, s55, v55
  v_mfma_f32_16x16x32_bf16 v[152:155], v[24:27], v[96:99], v[152:155]
  ds_read_b128 v[120:123], v78 offset:51200
  v_and_b32 v60, s28, v40
  v_mfma_f32_16x16x32_bf16 v[156:159], v[28:31], v[96:99], v[156:159]
  s_waitcnt lgkmcnt(5)
  v_and_b32 v61, s29, v40
  v_lshrrev_b32 v64, 8, v40
  v_mfma_f32_16x16x32_bf16 v[164:167], v[28:31], v[100:103], v[164:167]
  ds_read_b128 v[124:127], v78 offset:53248
  v_fma_mix_f32 v65, v60, v48, v52 op_sel_hi:[1,0,0]
  v_mfma_f32_16x16x32_bf16 v[160:163], v[24:27], v[100:103], v[160:163]
  s_waitcnt lgkmcnt(5)
  v_fma_mix_f32 v66, v61, v50, v52 op_sel_hi:[1,0,0]
  v_and_b32 v62, s28, v64
  v_mfma_f32_16x16x32_bf16 v[168:171], v[24:27], v[104:107], v[168:171]
  ds_read_b128 v[88:91], v78 offset:55296
  v_and_b32 v63, s29, v64
  v_mfma_f32_16x16x32_bf16 v[172:175], v[28:31], v[104:107], v[172:175]
  s_waitcnt lgkmcnt(5)
  ds_read_u16_d16_hi v54, v81 offset:256
  v_fma_mix_f32 v67, v60, v48, v52 op_sel:[1,0,0] op_sel_hi:[1,0,0]
  v_mfma_f32_16x16x32_bf16 v[180:183], v[28:31], v[108:111], v[180:183]
  ds_read_b128 v[92:95], v78 offset:57344
  v_fma_mix_f32 v68, v61, v50, v52 op_sel:[1,0,0] op_sel_hi:[1,0,0]
  v_mfma_f32_16x16x32_bf16 v[176:179], v[24:27], v[108:111], v[176:179]
  s_waitcnt lgkmcnt(6)
  v_cvt_pk_bf16_f32 v8, v65, v66
  v_fma_mix_f32 v65, v62, v48, v52 op_sel_hi:[1,0,0]
  v_mfma_f32_16x16x32_bf16 v[184:187], v[24:27], v[112:115], v[184:187]
  ds_read_b128 v[96:99], v78 offset:59392
  v_fma_mix_f32 v66, v63, v50, v52 op_sel_hi:[1,0,0]
  v_mfma_f32_16x16x32_bf16 v[188:191], v[28:31], v[112:115], v[188:191]
  s_waitcnt lgkmcnt(6)
  v_cvt_pk_bf16_f32 v10, v67, v68
  v_fma_mix_f32 v67, v62, v48, v52 op_sel:[1,0,0] op_sel_hi:[1,0,0]
  v_mfma_f32_16x16x32_bf16 v[196:199], v[28:31], v[116:119], v[196:199]
  ds_read_b128 v[100:103], v78 offset:61440
  v_fma_mix_f32 v68, v63, v50, v52 op_sel:[1,0,0] op_sel_hi:[1,0,0]
  v_mfma_f32_16x16x32_bf16 v[192:195], v[24:27], v[116:119], v[192:195]
  s_waitcnt lgkmcnt(6)
  v_cvt_pk_bf16_f32 v9, v65, v66
  v_cvt_pk_bf16_f32 v11, v67, v68
  v_mfma_f32_16x16x32_bf16 v[200:203], v[24:27], v[120:123], v[200:203]
  ds_read_b128 v[104:107], v78 offset:63488
  v_and_b32 v69, s28, v41
  v_mfma_f32_16x16x32_bf16 v[204:207], v[28:31], v[120:123], v[204:207]
  s_waitcnt lgkmcnt(6)
  ds_read_u16_d16_hi v55, v81 offset:384
  v_xor_b32 v78, s43, v78
  v_mfma_f32_16x16x32_bf16 v[212:215], v[28:31], v[124:127], v[212:215]
  ds_read_b128 v[108:111], v79 offset:34816
  v_and_b32 v70, s29, v41
  v_mfma_f32_16x16x32_bf16 v[208:211], v[24:27], v[124:127], v[208:211]
  s_waitcnt lgkmcnt(7)
  v_lshrrev_b32 v73, 8, v41
  v_mfma_f32_16x16x32_bf16 v[216:219], v[24:27], v[88:91], v[216:219]
  ds_read_b128 v[112:115], v79 offset:36864
  v_fma_mix_f32 v74, v69, v49, v53 op_sel_hi:[1,0,0]
  v_mfma_f32_16x16x32_bf16 v[220:223], v[28:31], v[88:91], v[220:223]
  s_waitcnt lgkmcnt(6)
  v_fma_mix_f32 v75, v70, v51, v53 op_sel_hi:[1,0,0]
  v_and_b32 v71, s28, v73
  v_mfma_f32_16x16x32_bf16 v[228:231], v[28:31], v[92:95], v[228:231]
  ds_read_b128 v[116:119], v79 offset:38912
  v_and_b32 v72, s29, v73
  v_mfma_f32_16x16x32_bf16 v[224:227], v[24:27], v[92:95], v[224:227]
  s_waitcnt lgkmcnt(6)
  ds_read_u16_d16_hi v56, v81 offset:4352
  v_fma_mix_f32 v76, v69, v49, v53 op_sel:[1,0,0] op_sel_hi:[1,0,0]
  v_mfma_f32_16x16x32_bf16 v[232:235], v[24:27], v[96:99], v[232:235]
  ds_read_b128 v[120:123], v79 offset:40960
  v_fma_mix_f32 v77, v70, v51, v53 op_sel:[1,0,0] op_sel_hi:[1,0,0]
  v_mfma_f32_16x16x32_bf16 v[236:239], v[28:31], v[96:99], v[236:239]
  s_waitcnt lgkmcnt(7)
  v_cvt_pk_bf16_f32 v12, v74, v75
  v_fma_mix_f32 v74, v71, v49, v53 op_sel_hi:[1,0,0]
  v_mfma_f32_16x16x32_bf16 v[244:247], v[28:31], v[100:103], v[244:247]
  ds_read_b128 v[124:127], v79 offset:43008
  v_fma_mix_f32 v75, v72, v51, v53 op_sel_hi:[1,0,0]
  v_mfma_f32_16x16x32_bf16 v[240:243], v[24:27], v[100:103], v[240:243]
  s_waitcnt lgkmcnt(7)
  v_cvt_pk_bf16_f32 v14, v76, v77
  v_fma_mix_f32 v76, v71, v49, v53 op_sel:[1,0,0] op_sel_hi:[1,0,0]
  v_mfma_f32_16x16x32_bf16 v[248:251], v[24:27], v[104:107], v[248:251]
  s_waitcnt lgkmcnt(5)
  ds_read_b128 v[88:91], v79 offset:45056
  v_fma_mix_f32 v77, v72, v51, v53 op_sel:[1,0,0] op_sel_hi:[1,0,0]
  v_mfma_f32_16x16x32_bf16 v[136:139], v[32:35], v[108:111], v[136:139]
  ds_read_b128 v[92:95], v79 offset:47104
  v_cvt_pk_bf16_f32 v13, v74, v75
  v_mfma_f32_16x16x32_bf16 v[140:143], v[36:39], v[108:111], v[140:143]
  s_waitcnt lgkmcnt(6)
  ds_read_u16_d16_hi v57, v81 offset:4480
  v_cvt_pk_bf16_f32 v15, v76, v77
  v_mfma_f32_16x16x32_bf16 v[148:151], v[36:39], v[112:115], v[148:151]
  ds_read_b128 v[96:99], v79 offset:49152
  v_and_b32 v60, s28, v42
  v_mfma_f32_16x16x32_bf16 v[144:147], v[32:35], v[112:115], v[144:147]
  s_waitcnt lgkmcnt(7)
  v_and_b32 v61, s29, v42
  v_lshrrev_b32 v64, 8, v42
  v_mfma_f32_16x16x32_bf16 v[152:155], v[32:35], v[116:119], v[152:155]
  ds_read_b128 v[100:103], v79 offset:51200
  v_fma_mix_f32 v65, v60, v48, v52 op_sel_hi:[1,0,0]
  v_mfma_f32_16x16x32_bf16 v[156:159], v[36:39], v[116:119], v[156:159]
  s_waitcnt lgkmcnt(6)
  v_fma_mix_f32 v66, v61, v50, v52 op_sel_hi:[1,0,0]
  v_and_b32 v62, s28, v64
  v_mfma_f32_16x16x32_bf16 v[164:167], v[36:39], v[120:123], v[164:167]
  ds_read_b128 v[104:107], v79 offset:53248
  v_and_b32 v63, s29, v64
  v_mfma_f32_16x16x32_bf16 v[160:163], v[32:35], v[120:123], v[160:163]
  s_waitcnt lgkmcnt(6)
  v_fma_mix_f32 v67, v60, v48, v52 op_sel:[1,0,0] op_sel_hi:[1,0,0]
  v_fma_mix_f32 v68, v61, v50, v52 op_sel:[1,0,0] op_sel_hi:[1,0,0]
  v_mfma_f32_16x16x32_bf16 v[168:171], v[32:35], v[124:127], v[168:171]
  ds_read_b128 v[108:111], v79 offset:55296
  v_cvt_pk_bf16_f32 v16, v65, v66
  v_mfma_f32_16x16x32_bf16 v[172:175], v[36:39], v[124:127], v[172:175]
  s_waitcnt lgkmcnt(6)
  v_fma_mix_f32 v65, v62, v48, v52 op_sel_hi:[1,0,0]
  v_mfma_f32_16x16x32_bf16 v[180:183], v[36:39], v[88:91], v[180:183]
  ds_read_b128 v[112:115], v79 offset:57344
  v_fma_mix_f32 v66, v63, v50, v52 op_sel_hi:[1,0,0]
  v_mfma_f32_16x16x32_bf16 v[176:179], v[32:35], v[88:91], v[176:179]
  s_waitcnt lgkmcnt(6)
  v_cvt_pk_bf16_f32 v18, v67, v68
  v_fma_mix_f32 v67, v62, v48, v52 op_sel:[1,0,0] op_sel_hi:[1,0,0]
  v_mfma_f32_16x16x32_bf16 v[184:187], v[32:35], v[92:95], v[184:187]
  ds_read_b128 v[116:119], v79 offset:59392
  v_fma_mix_f32 v68, v63, v50, v52 op_sel:[1,0,0] op_sel_hi:[1,0,0]
  v_mfma_f32_16x16x32_bf16 v[188:191], v[36:39], v[92:95], v[188:191]
  s_waitcnt lgkmcnt(5)
  v_cvt_pk_bf16_f32 v17, v65, v66
  v_cvt_pk_bf16_f32 v19, v67, v68
  v_mfma_f32_16x16x32_bf16 v[196:199], v[36:39], v[96:99], v[196:199]
  ds_read_b128 v[120:123], v79 offset:61440
  v_and_b32 v69, s28, v43
  v_mfma_f32_16x16x32_bf16 v[192:195], v[32:35], v[96:99], v[192:195]
  s_waitcnt lgkmcnt(5)
  v_and_b32 v70, s29, v43
  v_lshrrev_b32 v73, 8, v43
  v_mfma_f32_16x16x32_bf16 v[200:203], v[32:35], v[100:103], v[200:203]
  ds_read_b128 v[124:127], v79 offset:63488
  v_fma_mix_f32 v74, v69, v49, v53 op_sel_hi:[1,0,0]
  v_mfma_f32_16x16x32_bf16 v[204:207], v[36:39], v[100:103], v[204:207]
  s_waitcnt lgkmcnt(5)
  v_fma_mix_f32 v75, v70, v51, v53 op_sel_hi:[1,0,0]
  v_xor_b32 v79, s43, v79
  v_mfma_f32_16x16x32_bf16 v[212:215], v[36:39], v[104:107], v[212:215]
  s_barrier
  ds_read_b128 v[88:91], v78 offset:0
  v_and_b32 v71, s28, v73
  v_mfma_f32_16x16x32_bf16 v[208:211], v[32:35], v[104:107], v[208:211]
  s_waitcnt lgkmcnt(5)
  ds_read2st64_b32 v[44:45], v80 offset0:0 offset1:1
  v_and_b32 v72, s29, v73
  v_mfma_f32_16x16x32_bf16 v[216:219], v[32:35], v[108:111], v[216:219]
  ds_read_b128 v[92:95], v78 offset:2048
  v_fma_mix_f32 v76, v69, v49, v53 op_sel:[1,0,0] op_sel_hi:[1,0,0]
  v_mfma_f32_16x16x32_bf16 v[220:223], v[36:39], v[108:111], v[220:223]
  s_waitcnt lgkmcnt(6)
  ds_read2st64_b32 v[46:47], v80 offset0:8 offset1:9
  v_fma_mix_f32 v77, v70, v51, v53 op_sel:[1,0,0] op_sel_hi:[1,0,0]
  v_mfma_f32_16x16x32_bf16 v[228:231], v[36:39], v[112:115], v[228:231]
  ds_read_b128 v[96:99], v78 offset:4096
  v_cvt_pk_bf16_f32 v20, v74, v75
  v_mfma_f32_16x16x32_bf16 v[224:227], v[32:35], v[112:115], v[224:227]
  s_waitcnt lgkmcnt(7)
  v_fma_mix_f32 v74, v71, v49, v53 op_sel_hi:[1,0,0]
  v_fma_mix_f32 v75, v72, v51, v53 op_sel_hi:[1,0,0]
  v_mfma_f32_16x16x32_bf16 v[232:235], v[32:35], v[116:119], v[232:235]
  ds_read_b128 v[100:103], v78 offset:6144
  v_cvt_pk_bf16_f32 v22, v76, v77
  v_mfma_f32_16x16x32_bf16 v[236:239], v[36:39], v[116:119], v[236:239]
  s_waitcnt lgkmcnt(7)
  v_fma_mix_f32 v76, v71, v49, v53 op_sel:[1,0,0] op_sel_hi:[1,0,0]
  v_fma_mix_f32 v77, v72, v51, v53 op_sel:[1,0,0] op_sel_hi:[1,0,0]
  v_mfma_f32_16x16x32_bf16 v[244:247], v[36:39], v[120:123], v[244:247]
  ds_read_b128 v[104:107], v78 offset:8192
  v_cvt_pk_bf16_f32 v21, v74, v75
  v_mfma_f32_16x16x32_bf16 v[240:243], v[32:35], v[120:123], v[240:243]
  s_waitcnt lgkmcnt(6)
  v_cvt_pk_bf16_f32 v23, v76, v77
  v_mfma_f32_16x16x32_bf16 v[248:251], v[32:35], v[124:127], v[248:251]
  ds_read_b128 v[108:111], v78 offset:10240
  s_branch CLH
.p2align 12
TCH:
  s_branch CP
SPH:
SQH:
  s_endpgm
.p2align 3
FAH:
  v_mfma_f32_16x16x32_bf16 v[136:139], v[24:27], v[88:91], v[136:139]
  ds_read_b128 v[112:115], v79 offset:34816
  v_mul_f32 v48, s54, v54
  v_mul_f32 v52, -v56, v54
  v_mfma_f32_16x16x32_bf16 v[140:143], v[28:31], v[88:91], v[140:143]
  s_waitcnt lgkmcnt(6)
  v_mul_f32 v50, s55, v54
  v_mul_f32 v49, s54, v55
  v_mul_f32 v53, -v57, v55
  v_mfma_f32_16x16x32_bf16 v[144:147], v[24:27], v[92:95], v[144:147]
  ds_read_b128 v[116:119], v82 offset:0
  v_mul_f32 v51, s55, v55
  v_and_b32 v60, s28, v40
  v_mfma_f32_16x16x32_bf16 v[148:151], v[28:31], v[92:95], v[148:151]
  s_waitcnt lgkmcnt(5)
  v_and_b32 v61, s29, v40
  v_lshrrev_b32 v64, 8, v40
  v_fma_mix_f32 v65, v60, v48, v52 op_sel_hi:[1,0,0]
  v_mfma_f32_16x16x32_bf16 v[152:155], v[24:27], v[96:99], v[152:155]
  ds_read_b128 v[120:123], v87 offset:0
  v_fma_mix_f32 v66, v61, v50, v52 op_sel_hi:[1,0,0]
  v_and_b32 v62, s28, v64
  v_mfma_f32_16x16x32_bf16 v[156:159], v[28:31], v[96:99], v[156:159]
  s_waitcnt lgkmcnt(5)
  v_and_b32 v63, s29, v64
  v_fma_mix_f32 v67, v60, v48, v52 op_sel:[1,0,0] op_sel_hi:[1,0,0]
  v_fma_mix_f32 v68, v61, v50, v52 op_sel:[1,0,0] op_sel_hi:[1,0,0]
  v_mfma_f32_16x16x32_bf16 v[160:163], v[24:27], v[100:103], v[160:163]
  ds_read_b128 v[124:127], v79 offset:36864
  v_cvt_pk_bf16_f32 v8, v65, v66
  v_fma_mix_f32 v65, v62, v48, v52 op_sel_hi:[1,0,0]
  v_mfma_f32_16x16x32_bf16 v[164:167], v[28:31], v[100:103], v[164:167]
  s_waitcnt lgkmcnt(5)
  v_fma_mix_f32 v66, v63, v50, v52 op_sel_hi:[1,0,0]
  v_cvt_pk_bf16_f32 v10, v67, v68
  v_fma_mix_f32 v67, v62, v48, v52 op_sel:[1,0,0] op_sel_hi:[1,0,0]
  v_mfma_f32_16x16x32_bf16 v[168:171], v[24:27], v[104:107], v[168:171]
  ds_read_b128 v[88:91], v82 offset:2048
  v_fma_mix_f32 v68, v63, v50, v52 op_sel:[1,0,0] op_sel_hi:[1,0,0]
  v_cvt_pk_bf16_f32 v9, v65, v66
  v_mfma_f32_16x16x32_bf16 v[172:175], v[28:31], v[104:107], v[172:175]
  s_waitcnt lgkmcnt(5)
  v_cvt_pk_bf16_f32 v11, v67, v68
  v_and_b32 v69, s28, v41
  v_and_b32 v70, s29, v41
  v_mfma_f32_16x16x32_bf16 v[176:179], v[24:27], v[108:111], v[176:179]
  ds_read_b128 v[92:95], v87 offset:2048
  v_lshrrev_b32 v73, 8, v41
  v_fma_mix_f32 v74, v69, v49, v53 op_sel_hi:[1,0,0]
  v_mfma_f32_16x16x32_bf16 v[180:183], v[28:31], v[108:111], v[180:183]
  s_waitcnt lgkmcnt(5)
  v_fma_mix_f32 v75, v70, v51, v53 op_sel_hi:[1,0,0]
  v_and_b32 v71, s28, v73
  v_and_b32 v72, s29, v73
  v_mfma_f32_16x16x32_bf16 v[136:139], v[32:35], v[112:115], v[136:139]
  ds_read_b128 v[96:99], v79 offset:38912
  v_fma_mix_f32 v76, v69, v49, v53 op_sel:[1,0,0] op_sel_hi:[1,0,0]
  v_fma_mix_f32 v77, v70, v51, v53 op_sel:[1,0,0] op_sel_hi:[1,0,0]
  v_mfma_f32_16x16x32_bf16 v[140:143], v[36:39], v[112:115], v[140:143]
  s_waitcnt lgkmcnt(5)
  v_cvt_pk_bf16_f32 v12, v74, v75
  v_fma_mix_f32 v74, v71, v49, v53 op_sel_hi:[1,0,0]
  v_fma_mix_f32 v75, v72, v51, v53 op_sel_hi:[1,0,0]
  v_mfma_f32_16x16x32_bf16 v[136:139], v[0:3], v[116:119], v[136:139]
  ds_read_b128 v[100:103], v82 offset:4096
  v_cvt_pk_bf16_f32 v14, v76, v77
  v_fma_mix_f32 v76, v71, v49, v53 op_sel:[1,0,0] op_sel_hi:[1,0,0]
  v_mfma_f32_16x16x32_bf16 v[140:143], v[4:7], v[116:119], v[140:143]
  s_waitcnt lgkmcnt(5)
  v_fma_mix_f32 v77, v72, v51, v53 op_sel:[1,0,0] op_sel_hi:[1,0,0]
  v_cvt_pk_bf16_f32 v13, v74, v75
  v_cvt_pk_bf16_f32 v15, v76, v77
  v_mfma_f32_16x16x32_bf16 v[136:139], v[128:131], v[120:123], v[136:139]
  ds_read_b128 v[104:107], v82 offset:20480
  v_and_b32 v60, s28, v42
  v_and_b32 v61, s29, v42
  v_mfma_f32_16x16x32_bf16 v[140:143], v[132:135], v[120:123], v[140:143]
  s_waitcnt lgkmcnt(5)
  v_lshrrev_b32 v64, 8, v42
  v_fma_mix_f32 v65, v60, v48, v52 op_sel_hi:[1,0,0]
  v_fma_mix_f32 v66, v61, v50, v52 op_sel_hi:[1,0,0]
  v_mfma_f32_16x16x32_bf16 v[144:147], v[32:35], v[124:127], v[144:147]
  ds_read_b128 v[108:111], v87 offset:20480
  v_and_b32 v62, s28, v64
  v_and_b32 v63, s29, v64
  v_mfma_f32_16x16x32_bf16 v[148:151], v[36:39], v[124:127], v[148:151]
  s_waitcnt lgkmcnt(5)
  v_fma_mix_f32 v67, v60, v48, v52 op_sel:[1,0,0] op_sel_hi:[1,0,0]
  v_fma_mix_f32 v68, v61, v50, v52 op_sel:[1,0,0] op_sel_hi:[1,0,0]
  v_cvt_pk_bf16_f32 v16, v65, v66
  v_mfma_f32_16x16x32_bf16 v[144:147], v[0:3], v[88:91], v[144:147]
  ds_read_b128 v[112:115], v82 offset:22528
  v_fma_mix_f32 v65, v62, v48, v52 op_sel_hi:[1,0,0]
  v_fma_mix_f32 v66, v63, v50, v52 op_sel_hi:[1,0,0]
  v_mfma_f32_16x16x32_bf16 v[148:151], v[4:7], v[88:91], v[148:151]
  s_waitcnt lgkmcnt(5)
  v_cvt_pk_bf16_f32 v18, v67, v68
  v_fma_mix_f32 v67, v62, v48, v52 op_sel:[1,0,0] op_sel_hi:[1,0,0]
  v_fma_mix_f32 v68, v63, v50, v52 op_sel:[1,0,0] op_sel_hi:[1,0,0]
  v_mfma_f32_16x16x32_bf16 v[144:147], v[128:131], v[92:95], v[144:147]
  ds_read_b128 v[116:119], v87 offset:22528
  v_cvt_pk_bf16_f32 v17, v65, v66
  v_cvt_pk_bf16_f32 v19, v67, v68
  v_mfma_f32_16x16x32_bf16 v[148:151], v[132:135], v[92:95], v[148:151]
  s_waitcnt lgkmcnt(5)
  v_and_b32 v69, s28, v43
  v_and_b32 v70, s29, v43
  v_lshrrev_b32 v73, 8, v43
  v_mfma_f32_16x16x32_bf16 v[152:155], v[32:35], v[96:99], v[152:155]
  ds_read_b128 v[120:123], v87 offset:4096
  v_fma_mix_f32 v74, v69, v49, v53 op_sel_hi:[1,0,0]
  v_fma_mix_f32 v75, v70, v51, v53 op_sel_hi:[1,0,0]
  v_mfma_f32_16x16x32_bf16 v[156:159], v[36:39], v[96:99], v[156:159]
  s_waitcnt lgkmcnt(5)
  v_and_b32 v71, s28, v73
  v_and_b32 v72, s29, v73
  v_fma_mix_f32 v76, v69, v49, v53 op_sel:[1,0,0] op_sel_hi:[1,0,0]
  v_mfma_f32_16x16x32_bf16 v[152:155], v[0:3], v[100:103], v[152:155]
  ds_read_b128 v[124:127], v82 offset:24576
  v_fma_mix_f32 v77, v70, v51, v53 op_sel:[1,0,0] op_sel_hi:[1,0,0]
  v_cvt_pk_bf16_f32 v20, v74, v75
  v_mfma_f32_16x16x32_bf16 v[156:159], v[4:7], v[100:103], v[156:159]
  s_waitcnt lgkmcnt(5)
  v_fma_mix_f32 v74, v71, v49, v53 op_sel_hi:[1,0,0]
  v_fma_mix_f32 v75, v72, v51, v53 op_sel_hi:[1,0,0]
  v_cvt_pk_bf16_f32 v22, v76, v77
  v_mfma_f32_16x16x32_bf16 v[136:139], v[8:11], v[104:107], v[136:139]
  ds_read_b128 v[88:91], v87 offset:24576
  v_fma_mix_f32 v76, v71, v49, v53 op_sel:[1,0,0] op_sel_hi:[1,0,0]
  v_fma_mix_f32 v77, v72, v51, v53 op_sel:[1,0,0] op_sel_hi:[1,0,0]
  v_mfma_f32_16x16x32_bf16 v[140:143], v[12:15], v[104:107], v[140:143]
  s_waitcnt lgkmcnt(5)
  v_cvt_pk_bf16_f32 v21, v74, v75
  v_cvt_pk_bf16_f32 v23, v76, v77
  v_mfma_f32_16x16x32_bf16 v[136:139], v[16:19], v[108:111], v[136:139]
T1H:
  s_cbranch_vccnz LW
  ds_read_b128 v[92:95], v79 offset:40960
  v_mfma_f32_16x16x32_bf16 v[140:143], v[20:23], v[108:111], v[140:143]
  s_waitcnt lgkmcnt(5)
  v_mfma_f32_16x16x32_bf16 v[144:147], v[8:11], v[112:115], v[144:147]
  ds_read_b128 v[96:99], v82 offset:6144
  v_mfma_f32_16x16x32_bf16 v[148:151], v[12:15], v[112:115], v[148:151]
  s_waitcnt lgkmcnt(5)
  v_mfma_f32_16x16x32_bf16 v[144:147], v[16:19], v[116:119], v[144:147]
  ds_read_b128 v[100:103], v87 offset:6144
  v_mfma_f32_16x16x32_bf16 v[148:151], v[20:23], v[116:119], v[148:151]
  s_waitcnt lgkmcnt(5)
  v_cvt_pk_bf16_f32 v136, v136, v137
  v_cvt_pk_bf16_f32 v137, v138, v139
  v_mfma_f32_16x16x32_bf16 v[152:155], v[128:131], v[120:123], v[152:155]
  ds_read_b128 v[104:107], v82 offset:26624
  v_cvt_pk_bf16_f32 v138, v140, v141
  v_mfma_f32_16x16x32_bf16 v[156:159], v[132:135], v[120:123], v[156:159]
  s_waitcnt lgkmcnt(5)
  v_cvt_pk_bf16_f32 v139, v142, v143
  v_cvt_pk_bf16_f32 v144, v144, v145
  v_mfma_f32_16x16x32_bf16 v[152:155], v[8:11], v[124:127], v[152:155]
  ds_read_b128 v[108:111], v87 offset:26624
  v_cvt_pk_bf16_f32 v145, v146, v147
  v_mfma_f32_16x16x32_bf16 v[156:159], v[12:15], v[124:127], v[156:159]
  s_waitcnt lgkmcnt(5)
  ds_write_b64 v83, v[136:137] offset:0
  v_cvt_pk_bf16_f32 v146, v148, v149
  v_mfma_f32_16x16x32_bf16 v[152:155], v[16:19], v[88:91], v[152:155]
  ds_read_b128 v[112:115], v79 offset:43008
  v_cvt_pk_bf16_f32 v147, v150, v151
  v_mfma_f32_16x16x32_bf16 v[156:159], v[20:23], v[88:91], v[156:159]
  s_waitcnt lgkmcnt(6)
  ds_write_b64 v86, v[138:139] offset:2048
  v_mfma_f32_16x16x32_bf16 v[160:163], v[32:35], v[92:95], v[160:163]
  ds_read_b128 v[116:119], v82 offset:8192
  v_mfma_f32_16x16x32_bf16 v[164:167], v[36:39], v[92:95], v[164:167]
  s_waitcnt lgkmcnt(7)
  ds_write_b64 v83, v[144:145] offset:4096
  v_mfma_f32_16x16x32_bf16 v[160:163], v[0:3], v[96:99], v[160:163]
  ds_read_b128 v[120:123], v87 offset:8192
  v_cvt_pk_bf16_f32 v152, v152, v153
  v_mfma_f32_16x16x32_bf16 v[164:167], v[4:7], v[96:99], v[164:167]
  s_waitcnt lgkmcnt(8)
  ds_write_b64 v86, v[146:147] offset:6144
  v_cvt_pk_bf16_f32 v153, v154, v155
  v_mfma_f32_16x16x32_bf16 v[160:163], v[128:131], v[100:103], v[160:163]
  ds_read_b128 v[124:127], v82 offset:28672
  v_cvt_pk_bf16_f32 v154, v156, v157
  v_mfma_f32_16x16x32_bf16 v[164:167], v[132:135], v[100:103], v[164:167]
  s_waitcnt lgkmcnt(9)
  v_cvt_pk_bf16_f32 v155, v158, v159
  v_mfma_f32_16x16x32_bf16 v[160:163], v[8:11], v[104:107], v[160:163]
  ds_read_b128 v[88:91], v87 offset:28672
  v_mfma_f32_16x16x32_bf16 v[164:167], v[12:15], v[104:107], v[164:167]
  s_waitcnt lgkmcnt(9)
  ds_write_b64 v83, v[152:153] offset:8192
  v_mfma_f32_16x16x32_bf16 v[160:163], v[16:19], v[108:111], v[160:163]
  ds_read_b128 v[92:95], v79 offset:45056
  v_mfma_f32_16x16x32_bf16 v[164:167], v[20:23], v[108:111], v[164:167]
  s_waitcnt lgkmcnt(9)
  ds_write_b64 v86, v[154:155] offset:10240
  v_mfma_f32_16x16x32_bf16 v[168:171], v[32:35], v[112:115], v[168:171]
  ds_read_b128 v[96:99], v82 offset:10240
  v_mfma_f32_16x16x32_bf16 v[172:175], v[36:39], v[112:115], v[172:175]
  s_waitcnt lgkmcnt(6)
  v_mfma_f32_16x16x32_bf16 v[168:171], v[0:3], v[116:119], v[168:171]
  s_barrier
  ds_read_b128 v[100:103], v87 offset:10240
  v_cvt_pk_bf16_f32 v160, v160, v161
  v_mfma_f32_16x16x32_bf16 v[172:175], v[4:7], v[116:119], v[172:175]
  v_cvt_pk_bf16_f32 v161, v162, v163
  v_cvt_pk_bf16_f32 v162, v164, v165
  v_mfma_f32_16x16x32_bf16 v[168:171], v[128:131], v[120:123], v[168:171]
  ds_read_b128 v[104:107], v82 offset:30720
  v_cvt_pk_bf16_f32 v163, v166, v167
  v_mfma_f32_16x16x32_bf16 v[172:175], v[132:135], v[120:123], v[172:175]
  s_waitcnt lgkmcnt(7)
  ds_write_b64 v83, v[160:161] offset:12288
  v_mfma_f32_16x16x32_bf16 v[168:171], v[8:11], v[124:127], v[168:171]
T2H:
  s_cbranch_vccnz LW
  ds_read_b128 v[108:111], v87 offset:30720
  v_mfma_f32_16x16x32_bf16 v[172:175], v[12:15], v[124:127], v[172:175]
  s_waitcnt lgkmcnt(8)
  ds_write_b64 v86, v[162:163] offset:14336
  v_mfma_f32_16x16x32_bf16 v[168:171], v[16:19], v[88:91], v[168:171]
  ds_read_b128 v[112:115], v78 offset:47104
  v_mfma_f32_16x16x32_bf16 v[172:175], v[20:23], v[88:91], v[172:175]
  s_waitcnt lgkmcnt(8)
  v_mfma_f32_16x16x32_bf16 v[176:179], v[32:35], v[92:95], v[176:179]
  ds_read_b128 v[116:119], v79 offset:47104
  v_mfma_f32_16x16x32_bf16 v[180:183], v[36:39], v[92:95], v[180:183]
  s_waitcnt lgkmcnt(7)
  v_mfma_f32_16x16x32_bf16 v[176:179], v[0:3], v[96:99], v[176:179]
  ds_read_b128 v[120:123], v82 offset:12288
  v_mfma_f32_16x16x32_bf16 v[180:183], v[4:7], v[96:99], v[180:183]
  s_waitcnt lgkmcnt(7)
  v_cvt_pk_bf16_f32 v168, v168, v169
  v_cvt_pk_bf16_f32 v169, v170, v171
  v_mfma_f32_16x16x32_bf16 v[176:179], v[128:131], v[100:103], v[176:179]
  ds_read_b128 v[124:127], v87 offset:12288
  v_cvt_pk_bf16_f32 v170, v172, v173
  v_mfma_f32_16x16x32_bf16 v[180:183], v[132:135], v[100:103], v[180:183]
  s_waitcnt lgkmcnt(4)
  v_cvt_pk_bf16_f32 v171, v174, v175
  v_mfma_f32_16x16x32_bf16 v[176:179], v[8:11], v[104:107], v[176:179]
  s_barrier
  ds_read_b128 v[88:91], v82 offset:32768
  v_mfma_f32_16x16x32_bf16 v[180:183], v[12:15], v[104:107], v[180:183]
  ds_write_b64 v83, v[168:169] offset:16384
  v_mfma_f32_16x16x32_bf16 v[176:179], v[16:19], v[108:111], v[176:179]
  ds_read_b128 v[92:95], v87 offset:32768
  v_mfma_f32_16x16x32_bf16 v[180:183], v[20:23], v[108:111], v[180:183]
  s_waitcnt lgkmcnt(6)
  ds_write_b64 v86, v[170:171] offset:18432
  v_mfma_f32_16x16x32_bf16 v[184:187], v[24:27], v[112:115], v[184:187]
  ds_read_b128 v[96:99], v78 offset:49152
  v_mfma_f32_16x16x32_bf16 v[188:191], v[28:31], v[112:115], v[188:191]
  s_waitcnt lgkmcnt(7)
  v_mfma_f32_16x16x32_bf16 v[184:187], v[32:35], v[116:119], v[184:187]
  ds_read_b128 v[100:103], v79 offset:49152
  v_cvt_pk_bf16_f32 v176, v176, v177
  v_mfma_f32_16x16x32_bf16 v[188:191], v[36:39], v[116:119], v[188:191]
  s_waitcnt lgkmcnt(7)
  v_cvt_pk_bf16_f32 v177, v178, v179
  v_cvt_pk_bf16_f32 v178, v180, v181
  v_mfma_f32_16x16x32_bf16 v[184:187], v[0:3], v[120:123], v[184:187]
  ds_read_b128 v[104:107], v82 offset:14336
  v_cvt_pk_bf16_f32 v179, v182, v183
  v_mfma_f32_16x16x32_bf16 v[188:191], v[4:7], v[120:123], v[188:191]
  s_waitcnt lgkmcnt(7)
  ds_write_b64 v83, v[176:177] offset:20480
  v_mfma_f32_16x16x32_bf16 v[184:187], v[128:131], v[124:127], v[184:187]
  ds_read_b128 v[108:111], v87 offset:14336
  v_mfma_f32_16x16x32_bf16 v[188:191], v[132:135], v[124:127], v[188:191]
  s_waitcnt lgkmcnt(8)
  ds_write_b64 v86, v[178:179] offset:22528
  v_mfma_f32_16x16x32_bf16 v[184:187], v[8:11], v[88:91], v[184:187]
  ds_read_b128 v[112:115], v82 offset:34816
  v_mfma_f32_16x16x32_bf16 v[188:191], v[12:15], v[88:91], v[188:191]
  s_waitcnt lgkmcnt(8)
  v_mfma_f32_16x16x32_bf16 v[184:187], v[16:19], v[92:95], v[184:187]
  ds_read_b128 v[116:119], v87 offset:34816
  v_mfma_f32_16x16x32_bf16 v[188:191], v[20:23], v[92:95], v[188:191]
  s_waitcnt lgkmcnt(7)
  v_mfma_f32_16x16x32_bf16 v[192:195], v[24:27], v[96:99], v[192:195]
  ds_read_b128 v[120:123], v78 offset:51200
  v_mfma_f32_16x16x32_bf16 v[196:199], v[28:31], v[96:99], v[196:199]
  s_waitcnt lgkmcnt(7)
  v_mfma_f32_16x16x32_bf16 v[192:195], v[32:35], v[100:103], v[192:195]
  ds_read_b128 v[124:127], v79 offset:51200
  v_mfma_f32_16x16x32_bf16 v[196:199], v[36:39], v[100:103], v[196:199]
  s_waitcnt lgkmcnt(4)
  v_cvt_pk_bf16_f32 v184, v184, v185
  v_cvt_pk_bf16_f32 v185, v186, v187
  v_mfma_f32_16x16x32_bf16 v[192:195], v[0:3], v[104:107], v[192:195]
  s_barrier
  ds_read_b128 v[88:91], v82 offset:51200
  v_cvt_pk_bf16_f32 v186, v188, v189
  v_mfma_f32_16x16x32_bf16 v[196:199], v[4:7], v[104:107], v[196:199]
T3H:
  s_cbranch_vccnz LW
  v_cvt_pk_bf16_f32 v187, v190, v191
  v_mfma_f32_16x16x32_bf16 v[192:195], v[128:131], v[108:111], v[192:195]
  ds_read_b128 v[92:95], v87 offset:51200
  v_mfma_f32_16x16x32_bf16 v[196:199], v[132:135], v[108:111], v[196:199]
  s_waitcnt lgkmcnt(5)
  ds_write_b64 v83, v[184:185] offset:24576
  v_mfma_f32_16x16x32_bf16 v[192:195], v[8:11], v[112:115], v[192:195]
  ds_read_b128 v[96:99], v82 offset:36864
  v_mfma_f32_16x16x32_bf16 v[196:199], v[12:15], v[112:115], v[196:199]
  s_waitcnt lgkmcnt(6)
  ds_write_b64 v86, v[186:187] offset:26624
  v_mfma_f32_16x16x32_bf16 v[192:195], v[16:19], v[116:119], v[192:195]
  ds_read_b128 v[100:103], v87 offset:36864
  v_mfma_f32_16x16x32_bf16 v[196:199], v[20:23], v[116:119], v[196:199]
  s_waitcnt lgkmcnt(7)
  v_mfma_f32_16x16x32_bf16 v[200:203], v[24:27], v[120:123], v[200:203]
  ds_read_b128 v[104:107], v78 offset:53248
  v_mfma_f32_16x16x32_bf16 v[204:207], v[28:31], v[120:123], v[204:207]
  s_waitcnt lgkmcnt(7)
  v_mfma_f32_16x16x32_bf16 v[200:203], v[32:35], v[124:127], v[200:203]
  ds_read_b128 v[108:111], v79 offset:53248
  v_mfma_f32_16x16x32_bf16 v[204:207], v[36:39], v[124:127], v[204:207]
  s_waitcnt lgkmcnt(7)
  v_cvt_pk_bf16_f32 v192, v192, v193
  v_cvt_pk_bf16_f32 v193, v194, v195
  v_mfma_f32_16x16x32_bf16 v[200:203], v[0:3], v[88:91], v[200:203]
  ds_read_b128 v[112:115], v82 offset:53248
  v_cvt_pk_bf16_f32 v194, v196, v197
  v_mfma_f32_16x16x32_bf16 v[204:207], v[4:7], v[88:91], v[204:207]
  s_waitcnt lgkmcnt(7)
  v_cvt_pk_bf16_f32 v195, v198, v199
  v_mfma_f32_16x16x32_bf16 v[200:203], v[128:131], v[92:95], v[200:203]
  ds_read_b128 v[116:119], v87 offset:53248
  v_mfma_f32_16x16x32_bf16 v[204:207], v[132:135], v[92:95], v[204:207]
  s_waitcnt lgkmcnt(6)
  ds_write_b64 v83, v[192:193] offset:28672
  v_mfma_f32_16x16x32_bf16 v[200:203], v[8:11], v[96:99], v[200:203]
  ds_read_b128 v[120:123], v82 offset:38912
  v_mfma_f32_16x16x32_bf16 v[204:207], v[12:15], v[96:99], v[204:207]
  s_waitcnt lgkmcnt(6)
  ds_write_b64 v86, v[194:195] offset:30720
  v_mfma_f32_16x16x32_bf16 v[200:203], v[16:19], v[100:103], v[200:203]
  ds_read_b128 v[124:127], v87 offset:38912
  v_mfma_f32_16x16x32_bf16 v[204:207], v[20:23], v[100:103], v[204:207]
  s_waitcnt lgkmcnt(7)
  v_mfma_f32_16x16x32_bf16 v[208:211], v[24:27], v[104:107], v[208:211]
  ds_read_b128 v[88:91], v78 offset:55296
  v_mfma_f32_16x16x32_bf16 v[212:215], v[28:31], v[104:107], v[212:215]
  s_waitcnt lgkmcnt(7)
  v_mfma_f32_16x16x32_bf16 v[208:211], v[32:35], v[108:111], v[208:211]
  ds_read_b128 v[92:95], v79 offset:55296
  v_mfma_f32_16x16x32_bf16 v[212:215], v[36:39], v[108:111], v[212:215]
  s_waitcnt lgkmcnt(7)
  v_cvt_pk_bf16_f32 v200, v200, v201
  v_cvt_pk_bf16_f32 v201, v202, v203
  v_mfma_f32_16x16x32_bf16 v[208:211], v[0:3], v[112:115], v[208:211]
  ds_read_b128 v[96:99], v82 offset:55296
  v_cvt_pk_bf16_f32 v202, v204, v205
  v_mfma_f32_16x16x32_bf16 v[212:215], v[4:7], v[112:115], v[212:215]
  s_waitcnt lgkmcnt(4)
  v_cvt_pk_bf16_f32 v203, v206, v207
  v_mfma_f32_16x16x32_bf16 v[208:211], v[128:131], v[116:119], v[208:211]
  s_barrier
  ds_read_b128 v[100:103], v87 offset:55296
  v_mfma_f32_16x16x32_bf16 v[212:215], v[132:135], v[116:119], v[212:215]
  ds_write_b64 v83, v[200:201] offset:32768
  v_mfma_f32_16x16x32_bf16 v[208:211], v[8:11], v[120:123], v[208:211]
  ds_read_b128 v[104:107], v82 offset:40960
  v_mfma_f32_16x16x32_bf16 v[212:215], v[12:15], v[120:123], v[212:215]
  s_waitcnt lgkmcnt(6)
  ds_write_b64 v86, v[202:203] offset:34816
  v_mfma_f32_16x16x32_bf16 v[208:211], v[16:19], v[124:127], v[208:211]
  ds_read_b128 v[108:111], v87 offset:40960
  v_mfma_f32_16x16x32_bf16 v[212:215], v[20:23], v[124:127], v[212:215]
  s_waitcnt lgkmcnt(7)
  v_mfma_f32_16x16x32_bf16 v[216:219], v[24:27], v[88:91], v[216:219]
  ds_read_b128 v[112:115], v78 offset:57344
  v_mfma_f32_16x16x32_bf16 v[220:223], v[28:31], v[88:91], v[220:223]
  s_waitcnt lgkmcnt(7)
  v_mfma_f32_16x16x32_bf16 v[216:219], v[32:35], v[92:95], v[216:219]
T4H:
  s_cbranch_vccnz LW
  ds_read_b128 v[116:119], v79 offset:57344
  v_cvt_pk_bf16_f32 v208, v208, v209
  v_mfma_f32_16x16x32_bf16 v[220:223], v[36:39], v[92:95], v[220:223]
  s_waitcnt lgkmcnt(7)
  v_cvt_pk_bf16_f32 v209, v210, v211
  v_cvt_pk_bf16_f32 v210, v212, v213
  v_mfma_f32_16x16x32_bf16 v[216:219], v[0:3], v[96:99], v[216:219]
  ds_read_b128 v[120:123], v82 offset:57344
  v_cvt_pk_bf16_f32 v211, v214, v215
  v_mfma_f32_16x16x32_bf16 v[220:223], v[4:7], v[96:99], v[220:223]
  s_waitcnt lgkmcnt(7)
  ds_write_b64 v83, v[208:209] offset:36864
  v_mfma_f32_16x16x32_bf16 v[216:219], v[128:131], v[100:103], v[216:219]
  ds_read_b128 v[124:127], v87 offset:57344
  v_mfma_f32_16x16x32_bf16 v[220:223], v[132:135], v[100:103], v[220:223]
  s_waitcnt lgkmcnt(7)
  ds_write_b64 v86, v[210:211] offset:38912
  v_mfma_f32_16x16x32_bf16 v[216:219], v[8:11], v[104:107], v[216:219]
  ds_read_b128 v[88:91], v82 offset:43008
  v_mfma_f32_16x16x32_bf16 v[220:223], v[12:15], v[104:107], v[220:223]
  s_waitcnt lgkmcnt(7)
  v_mfma_f32_16x16x32_bf16 v[216:219], v[16:19], v[108:111], v[216:219]
  ds_read_b128 v[92:95], v87 offset:43008
  v_mfma_f32_16x16x32_bf16 v[220:223], v[20:23], v[108:111], v[220:223]
  s_waitcnt lgkmcnt(7)
  v_mfma_f32_16x16x32_bf16 v[224:227], v[24:27], v[112:115], v[224:227]
  ds_read_b128 v[96:99], v78 offset:59392
  v_mfma_f32_16x16x32_bf16 v[228:231], v[28:31], v[112:115], v[228:231]
  s_waitcnt lgkmcnt(7)
  v_mfma_f32_16x16x32_bf16 v[224:227], v[32:35], v[116:119], v[224:227]
  ds_read_b128 v[100:103], v79 offset:59392
  v_mfma_f32_16x16x32_bf16 v[228:231], v[36:39], v[116:119], v[228:231]
  s_waitcnt lgkmcnt(4)
  v_cvt_pk_bf16_f32 v216, v216, v217
  v_cvt_pk_bf16_f32 v217, v218, v219
  v_mfma_f32_16x16x32_bf16 v[224:227], v[0:3], v[120:123], v[224:227]
  s_barrier
  ds_read_b128 v[104:107], v82 offset:59392
  v_cvt_pk_bf16_f32 v218, v220, v221
  v_mfma_f32_16x16x32_bf16 v[228:231], v[4:7], v[120:123], v[228:231]
  v_cvt_pk_bf16_f32 v219, v222, v223
  v_mfma_f32_16x16x32_bf16 v[224:227], v[128:131], v[124:127], v[224:227]
  ds_read_b128 v[108:111], v87 offset:59392
  v_mfma_f32_16x16x32_bf16 v[228:231], v[132:135], v[124:127], v[228:231]
  s_waitcnt lgkmcnt(5)
  ds_write_b64 v58, v[216:217] offset:0
  v_mfma_f32_16x16x32_bf16 v[224:227], v[8:11], v[88:91], v[224:227]
  ds_read_b128 v[112:115], v82 offset:45056
  v_mfma_f32_16x16x32_bf16 v[228:231], v[12:15], v[88:91], v[228:231]
  s_waitcnt lgkmcnt(6)
  ds_write_b64 v59, v[218:219] offset:2048
  v_mfma_f32_16x16x32_bf16 v[224:227], v[16:19], v[92:95], v[224:227]
  ds_read_b128 v[116:119], v87 offset:45056
  v_mfma_f32_16x16x32_bf16 v[228:231], v[20:23], v[92:95], v[228:231]
  s_waitcnt lgkmcnt(7)
  v_mfma_f32_16x16x32_bf16 v[232:235], v[24:27], v[96:99], v[232:235]
  ds_read_b128 v[120:123], v78 offset:61440
  v_mfma_f32_16x16x32_bf16 v[236:239], v[28:31], v[96:99], v[236:239]
  s_waitcnt lgkmcnt(7)
  v_mfma_f32_16x16x32_bf16 v[232:235], v[32:35], v[100:103], v[232:235]
  ds_read_b128 v[124:127], v79 offset:61440
  v_mfma_f32_16x16x32_bf16 v[236:239], v[36:39], v[100:103], v[236:239]
  s_waitcnt lgkmcnt(7)
  v_cvt_pk_bf16_f32 v224, v224, v225
  v_cvt_pk_bf16_f32 v225, v226, v227
  v_mfma_f32_16x16x32_bf16 v[232:235], v[0:3], v[104:107], v[232:235]
  ds_read_b128 v[88:91], v82 offset:61440
  v_cvt_pk_bf16_f32 v226, v228, v229
  v_mfma_f32_16x16x32_bf16 v[236:239], v[4:7], v[104:107], v[236:239]
  s_waitcnt lgkmcnt(7)
  v_cvt_pk_bf16_f32 v227, v230, v231
  v_mfma_f32_16x16x32_bf16 v[232:235], v[128:131], v[108:111], v[232:235]
  ds_read_b128 v[92:95], v87 offset:61440
  v_mfma_f32_16x16x32_bf16 v[236:239], v[132:135], v[108:111], v[236:239]
  s_waitcnt lgkmcnt(6)
  ds_write_b64 v58, v[224:225] offset:4096
  v_mfma_f32_16x16x32_bf16 v[232:235], v[8:11], v[112:115], v[232:235]
  ds_read_b128 v[96:99], v82 offset:47104
  v_mfma_f32_16x16x32_bf16 v[236:239], v[12:15], v[112:115], v[236:239]
  s_waitcnt lgkmcnt(6)
  ds_write_b64 v59, v[226:227] offset:6144
  v_mfma_f32_16x16x32_bf16 v[232:235], v[16:19], v[116:119], v[232:235]
T5H:
  s_cbranch_vccnz LW
  ds_read_b128 v[100:103], v87 offset:47104
  v_mfma_f32_16x16x32_bf16 v[236:239], v[20:23], v[116:119], v[236:239]
  s_waitcnt lgkmcnt(7)
  v_mfma_f32_16x16x32_bf16 v[240:243], v[24:27], v[120:123], v[240:243]
  ds_read_b128 v[104:107], v78 offset:63488
  v_mfma_f32_16x16x32_bf16 v[244:247], v[28:31], v[120:123], v[244:247]
  s_waitcnt lgkmcnt(7)
  v_mfma_f32_16x16x32_bf16 v[240:243], v[32:35], v[124:127], v[240:243]
  ds_read_b128 v[108:111], v79 offset:63488
  v_mfma_f32_16x16x32_bf16 v[244:247], v[36:39], v[124:127], v[244:247]
  s_waitcnt lgkmcnt(7)
  v_cvt_pk_bf16_f32 v232, v232, v233
  v_cvt_pk_bf16_f32 v233, v234, v235
  v_mfma_f32_16x16x32_bf16 v[240:243], v[0:3], v[88:91], v[240:243]
  ds_read_b128 v[112:115], v82 offset:63488
  v_cvt_pk_bf16_f32 v234, v236, v237
  v_mfma_f32_16x16x32_bf16 v[244:247], v[4:7], v[88:91], v[244:247]
  s_waitcnt lgkmcnt(4)
  v_cvt_pk_bf16_f32 v235, v238, v239
  v_mfma_f32_16x16x32_bf16 v[240:243], v[128:131], v[92:95], v[240:243]
  s_barrier
  ds_read_b128 v[116:119], v87 offset:63488
  v_mfma_f32_16x16x32_bf16 v[244:247], v[132:135], v[92:95], v[244:247]
  ds_write_b64 v58, v[232:233] offset:8192
  v_mfma_f32_16x16x32_bf16 v[240:243], v[8:11], v[96:99], v[240:243]
  ds_read_b128 v[120:123], v82 offset:49152
  v_mfma_f32_16x16x32_bf16 v[244:247], v[12:15], v[96:99], v[244:247]
  s_waitcnt lgkmcnt(6)
  ds_write_b64 v59, v[234:235] offset:10240
  v_mfma_f32_16x16x32_bf16 v[240:243], v[16:19], v[100:103], v[240:243]
  ds_read_b128 v[124:127], v87 offset:49152
  v_mfma_f32_16x16x32_bf16 v[244:247], v[20:23], v[100:103], v[244:247]
  s_waitcnt lgkmcnt(7)
  v_mfma_f32_16x16x32_bf16 v[248:251], v[24:27], v[104:107], v[248:251]
  s_waitcnt lgkmcnt(6)
  v_mfma_f32_16x16x32_bf16 v[248:251], v[32:35], v[108:111], v[248:251]
  s_waitcnt lgkmcnt(5)
  v_mfma_f32_16x16x32_bf16 v[248:251], v[0:3], v[112:115], v[248:251]
  s_waitcnt lgkmcnt(4)
  v_mfma_f32_16x16x32_bf16 v[248:251], v[128:131], v[116:119], v[248:251]
  s_waitcnt lgkmcnt(2)
  v_cvt_pk_bf16_f32 v240, v240, v241
  v_cvt_pk_bf16_f32 v241, v242, v243
  v_mfma_f32_16x16x32_bf16 v[248:251], v[8:11], v[120:123], v[248:251]
  s_waitcnt lgkmcnt(0)
  v_cvt_pk_bf16_f32 v242, v244, v245
  v_cvt_pk_bf16_f32 v243, v246, v247
  v_mfma_f32_16x16x32_bf16 v[248:251], v[16:19], v[124:127], v[248:251]
  ds_write_b64 v58, v[240:241] offset:12288
  ds_write_b64 v59, v[242:243] offset:14336
  s_nop 5
  v_cvt_pk_bf16_f32 v248, v248, v249
  v_cvt_pk_bf16_f32 v249, v250, v251
  ds_write_b64 v58, v[248:249] offset:16384
  s_waitcnt lgkmcnt(0)
  s_barrier
  s_endpgm
.p2align 12
CN:
  s_cbranch_vccnz CP
  v_mul_f32 v48, s54, v54
  v_mul_f32 v52, -v56, v54
  v_mul_f32 v50, s55, v54
  v_mul_f32 v49, s54, v55
  v_mul_f32 v53, -v57, v55
  v_mul_f32 v51, s55, v55
  s_waitcnt vmcnt(3)
  v_and_b32 v60, s28, v40
  v_and_b32 v61, s29, v40
  v_lshrrev_b32 v64, 8, v40
  v_fma_mix_f32 v65, v60, v48, v52 op_sel_hi:[1,0,0]
  v_fma_mix_f32 v66, v61, v50, v52 op_sel_hi:[1,0,0]
  v_and_b32 v62, s28, v64
  v_and_b32 v63, s29, v64
  v_fma_mix_f32 v67, v60, v48, v52 op_sel:[1,0,0] op_sel_hi:[1,0,0]
  v_fma_mix_f32 v68, v61, v50, v52 op_sel:[1,0,0] op_sel_hi:[1,0,0]
  v_cvt_pk_bf16_f32 v8, v65, v66
  v_fma_mix_f32 v65, v62, v48, v52 op_sel_hi:[1,0,0]
  v_fma_mix_f32 v66, v63, v50, v52 op_sel_hi:[1,0,0]
  v_cvt_pk_bf16_f32 v10, v67, v68
  v_fma_mix_f32 v67, v62, v48, v52 op_sel:[1,0,0] op_sel_hi:[1,0,0]
  v_fma_mix_f32 v68, v63, v50, v52 op_sel:[1,0,0] op_sel_hi:[1,0,0]
  v_cvt_pk_bf16_f32 v9, v65, v66
  v_cvt_pk_bf16_f32 v11, v67, v68
  s_waitcnt vmcnt(2)
  v_and_b32 v69, s28, v41
  v_and_b32 v70, s29, v41
  v_lshrrev_b32 v73, 8, v41
  v_fma_mix_f32 v74, v69, v49, v53 op_sel_hi:[1,0,0]
  v_fma_mix_f32 v75, v70, v51, v53 op_sel_hi:[1,0,0]
  v_and_b32 v71, s28, v73
  v_and_b32 v72, s29, v73
  v_fma_mix_f32 v76, v69, v49, v53 op_sel:[1,0,0] op_sel_hi:[1,0,0]
  v_fma_mix_f32 v77, v70, v51, v53 op_sel:[1,0,0] op_sel_hi:[1,0,0]
  v_cvt_pk_bf16_f32 v12, v74, v75
  v_fma_mix_f32 v74, v71, v49, v53 op_sel_hi:[1,0,0]
  v_fma_mix_f32 v75, v72, v51, v53 op_sel_hi:[1,0,0]
  v_cvt_pk_bf16_f32 v14, v76, v77
  v_fma_mix_f32 v76, v71, v49, v53 op_sel:[1,0,0] op_sel_hi:[1,0,0]
  v_fma_mix_f32 v77, v72, v51, v53 op_sel:[1,0,0] op_sel_hi:[1,0,0]
  v_cvt_pk_bf16_f32 v13, v74, v75
  v_cvt_pk_bf16_f32 v15, v76, v77
  s_waitcnt vmcnt(1)
  v_and_b32 v60, s28, v42
  v_and_b32 v61, s29, v42
  v_lshrrev_b32 v64, 8, v42
  v_fma_mix_f32 v65, v60, v48, v52 op_sel_hi:[1,0,0]
  v_fma_mix_f32 v66, v61, v50, v52 op_sel_hi:[1,0,0]
  v_and_b32 v62, s28, v64
  v_and_b32 v63, s29, v64
  v_fma_mix_f32 v67, v60, v48, v52 op_sel:[1,0,0] op_sel_hi:[1,0,0]
  v_fma_mix_f32 v68, v61, v50, v52 op_sel:[1,0,0] op_sel_hi:[1,0,0]
  v_cvt_pk_bf16_f32 v16, v65, v66
  s_waitcnt vmcnt(0)
  s_setprio 2
  s_barrier
  ds_read_b128 v[88:91], v78 offset:0
  v_fma_mix_f32 v65, v62, v48, v52 op_sel_hi:[1,0,0]
  v_fma_mix_f32 v66, v63, v50, v52 op_sel_hi:[1,0,0]
  ds_read_u16_d16_hi v54, v81 offset:256
  v_cvt_pk_bf16_f32 v18, v67, v68
  v_fma_mix_f32 v67, v62, v48, v52 op_sel:[1,0,0] op_sel_hi:[1,0,0]
  ds_read_u16_d16_hi v55, v81 offset:384
  v_fma_mix_f32 v68, v63, v50, v52 op_sel:[1,0,0] op_sel_hi:[1,0,0]
  v_cvt_pk_bf16_f32 v17, v65, v66
  ds_read_u16_d16_hi v56, v81 offset:4352
  v_cvt_pk_bf16_f32 v19, v67, v68
  v_and_b32 v69, s28, v43
  ds_read_u16_d16_hi v57, v81 offset:4480
  v_and_b32 v70, s29, v43
  v_lshrrev_b32 v73, 8, v43
  ds_read2st64_b32 v[44:45], v80 offset0:0 offset1:1
  v_fma_mix_f32 v74, v69, v49, v53 op_sel_hi:[1,0,0]
  v_fma_mix_f32 v75, v70, v51, v53 op_sel_hi:[1,0,0]
  ds_read_b128 v[92:95], v78 offset:2048
  v_and_b32 v71, s28, v73
  v_and_b32 v72, s29, v73
  ds_read2st64_b32 v[46:47], v80 offset0:8 offset1:9
  v_fma_mix_f32 v76, v69, v49, v53 op_sel:[1,0,0] op_sel_hi:[1,0,0]
  v_fma_mix_f32 v77, v70, v51, v53 op_sel:[1,0,0] op_sel_hi:[1,0,0]
  ds_read_b128 v[96:99], v78 offset:4096
  v_cvt_pk_bf16_f32 v20, v74, v75
  v_fma_mix_f32 v74, v71, v49, v53 op_sel_hi:[1,0,0]
  ds_read_b128 v[100:103], v78 offset:6144
  v_fma_mix_f32 v75, v72, v51, v53 op_sel_hi:[1,0,0]
  v_cvt_pk_bf16_f32 v22, v76, v77
  ds_read_b128 v[104:107], v78 offset:8192
  v_fma_mix_f32 v76, v71, v49, v53 op_sel:[1,0,0] op_sel_hi:[1,0,0]
  v_fma_mix_f32 v77, v72, v51, v53 op_sel:[1,0,0] op_sel_hi:[1,0,0]
  ds_read_b128 v[108:111], v78 offset:10240
  v_cvt_pk_bf16_f32 v21, v74, v75
  v_cvt_pk_bf16_f32 v23, v76, v77
  s_waitcnt lgkmcnt(7)
  s_nop 0
.p2align 3
CLN:
  v_mfma_f32_16x16x32_bf16 v[136:139], v[8:11], v[88:91], v[136:139]
  ds_read_b128 v[112:115], v78 offset:12288
  v_mul_f32 v48, s54, v54
  v_mfma_f32_16x16x32_bf16 v[140:143], v[12:15], v[88:91], v[140:143]
  s_waitcnt lgkmcnt(6)
  v_mul_f32 v52, -v56, v54
  v_add_u32 v81, s45, v81
  v_mfma_f32_16x16x32_bf16 v[148:151], v[12:15], v[92:95], v[148:151]
  ds_read_b128 v[116:119], v78 offset:14336
  v_mul_f32 v50, s55, v54
  v_mfma_f32_16x16x32_bf16 v[144:147], v[8:11], v[92:95], v[144:147]
  s_waitcnt lgkmcnt(5)
  v_mul_f32 v49, s54, v55
  v_mul_f32 v53, -v57, v55
  v_mfma_f32_16x16x32_bf16 v[152:155], v[8:11], v[96:99], v[152:155]
  ds_read_b128 v[120:123], v78 offset:16384
  v_mul_f32 v51, s55, v55
  v_mfma_f32_16x16x32_bf16 v[156:159], v[12:15], v[96:99], v[156:159]
  s_waitcnt lgkmcnt(5)
  v_and_b32 v60, s28, v44
  v_and_b32 v61, s29, v44
  v_mfma_f32_16x16x32_bf16 v[164:167], v[12:15], v[100:103], v[164:167]
  ds_read_b128 v[124:127], v78 offset:18432
  v_lshrrev_b32 v64, 8, v44
  v_mfma_f32_16x16x32_bf16 v[160:163], v[8:11], v[100:103], v[160:163]
  s_waitcnt lgkmcnt(5)
  v_fma_mix_f32 v65, v60, v48, v52 op_sel_hi:[1,0,0]
  v_fma_mix_f32 v66, v61, v50, v52 op_sel_hi:[1,0,0]
  v_mfma_f32_16x16x32_bf16 v[168:171], v[8:11], v[104:107], v[168:171]
  ds_read_b128 v[88:91], v78 offset:20480
  v_and_b32 v62, s28, v64
  v_mfma_f32_16x16x32_bf16 v[172:175], v[12:15], v[104:107], v[172:175]
  s_waitcnt lgkmcnt(5)
  ds_read_u16_d16_hi v54, v81 offset:0
  v_and_b32 v63, s29, v64
  v_mfma_f32_16x16x32_bf16 v[180:183], v[12:15], v[108:111], v[180:183]
  ds_read_b128 v[92:95], v78 offset:22528
  v_fma_mix_f32 v67, v60, v48, v52 op_sel:[1,0,0] op_sel_hi:[1,0,0]
  v_mfma_f32_16x16x32_bf16 v[176:179], v[8:11], v[108:111], v[176:179]
  s_waitcnt lgkmcnt(6)
  v_fma_mix_f32 v68, v61, v50, v52 op_sel:[1,0,0] op_sel_hi:[1,0,0]
  v_cvt_pk_bf16_f32 v24, v65, v66
  v_mfma_f32_16x16x32_bf16 v[184:187], v[8:11], v[112:115], v[184:187]
  ds_read_b128 v[96:99], v78 offset:24576
  v_fma_mix_f32 v65, v62, v48, v52 op_sel_hi:[1,0,0]
  v_mfma_f32_16x16x32_bf16 v[188:191], v[12:15], v[112:115], v[188:191]
  s_waitcnt lgkmcnt(6)
  v_fma_mix_f32 v66, v63, v50, v52 op_sel_hi:[1,0,0]
  v_cvt_pk_bf16_f32 v26, v67, v68
  v_mfma_f32_16x16x32_bf16 v[196:199], v[12:15], v[116:119], v[196:199]
  ds_read_b128 v[100:103], v78 offset:26624
  v_fma_mix_f32 v67, v62, v48, v52 op_sel:[1,0,0] op_sel_hi:[1,0,0]
  v_mfma_f32_16x16x32_bf16 v[192:195], v[8:11], v[116:119], v[192:195]
  s_waitcnt lgkmcnt(6)
  v_fma_mix_f32 v68, v63, v50, v52 op_sel:[1,0,0] op_sel_hi:[1,0,0]
  v_cvt_pk_bf16_f32 v25, v65, v66
  v_mfma_f32_16x16x32_bf16 v[200:203], v[8:11], v[120:123], v[200:203]
  ds_read_b128 v[104:107], v79 offset:0
  v_cvt_pk_bf16_f32 v27, v67, v68
  v_mfma_f32_16x16x32_bf16 v[204:207], v[12:15], v[120:123], v[204:207]
  s_waitcnt lgkmcnt(6)
  ds_read_u16_d16_hi v55, v81 offset:128
  v_and_b32 v69, s28, v45
  v_mfma_f32_16x16x32_bf16 v[212:215], v[12:15], v[124:127], v[212:215]
  ds_read_b128 v[108:111], v79 offset:2048
  v_and_b32 v70, s29, v45
  v_mfma_f32_16x16x32_bf16 v[208:211], v[8:11], v[124:127], v[208:211]
  s_waitcnt lgkmcnt(7)
  v_lshrrev_b32 v73, 8, v45
  v_fma_mix_f32 v74, v69, v49, v53 op_sel_hi:[1,0,0]
  v_mfma_f32_16x16x32_bf16 v[216:219], v[8:11], v[88:91], v[216:219]
  ds_read_b128 v[112:115], v79 offset:4096
  v_fma_mix_f32 v75, v70, v51, v53 op_sel_hi:[1,0,0]
  v_mfma_f32_16x16x32_bf16 v[220:223], v[12:15], v[88:91], v[220:223]
  s_waitcnt lgkmcnt(6)
  v_and_b32 v71, s28, v73
  v_and_b32 v72, s29, v73
  v_mfma_f32_16x16x32_bf16 v[228:231], v[12:15], v[92:95], v[228:231]
  ds_read_b128 v[116:119], v79 offset:6144
  v_fma_mix_f32 v76, v69, v49, v53 op_sel:[1,0,0] op_sel_hi:[1,0,0]
  v_mfma_f32_16x16x32_bf16 v[224:227], v[8:11], v[92:95], v[224:227]
  s_waitcnt lgkmcnt(6)
  ds_read_u16_d16_hi v56, v81 offset:4096
  v_fma_mix_f32 v77, v70, v51, v53 op_sel:[1,0,0] op_sel_hi:[1,0,0]
  v_mfma_f32_16x16x32_bf16 v[232:235], v[8:11], v[96:99], v[232:235]
  ds_read_b128 v[120:123], v79 offset:8192
  v_cvt_pk_bf16_f32 v28, v74, v75
  v_mfma_f32_16x16x32_bf16 v[236:239], v[12:15], v[96:99], v[236:239]
  s_waitcnt lgkmcnt(7)
  v_fma_mix_f32 v74, v71, v49, v53 op_sel_hi:[1,0,0]
  v_fma_mix_f32 v75, v72, v51, v53 op_sel_hi:[1,0,0]
  v_mfma_f32_16x16x32_bf16 v[244:247], v[12:15], v[100:103], v[244:247]
  ds_read_b128 v[124:127], v79 offset:10240
  v_cvt_pk_bf16_f32 v30, v76, v77
  v_mfma_f32_16x16x32_bf16 v[240:243], v[8:11], v[100:103], v[240:243]
  s_waitcnt lgkmcnt(7)
  v_fma_mix_f32 v76, v71, v49, v53 op_sel:[1,0,0] op_sel_hi:[1,0,0]
  v_fma_mix_f32 v77, v72, v51, v53 op_sel:[1,0,0] op_sel_hi:[1,0,0]
  v_mfma_f32_16x16x32_bf16 v[136:139], v[16:19], v[104:107], v[136:139]
  ds_read_b128 v[88:91], v79 offset:12288
  v_cvt_pk_bf16_f32 v29, v74, v75
  v_mfma_f32_16x16x32_bf16 v[140:143], v[20:23], v[104:107], v[140:143]
  s_waitcnt lgkmcnt(6)
  v_cvt_pk_bf16_f32 v31, v76, v77
  v_and_b32 v60, s28, v46
  v_mfma_f32_16x16x32_bf16 v[148:151], v[20:23], v[108:111], v[148:151]
  ds_read_b128 v[92:95], v79 offset:14336
  v_and_b32 v61, s29, v46
  v_mfma_f32_16x16x32_bf16 v[144:147], v[16:19], v[108:111], v[144:147]
  s_waitcnt lgkmcnt(6)
  ds_read_u16_d16_hi v57, v81 offset:4224
  v_lshrrev_b32 v64, 8, v46
  v_mfma_f32_16x16x32_bf16 v[152:155], v[16:19], v[112:115], v[152:155]
  ds_read_b128 v[96:99], v79 offset:16384
  v_fma_mix_f32 v65, v60, v48, v52 op_sel_hi:[1,0,0]
  v_mfma_f32_16x16x32_bf16 v[156:159], v[20:23], v[112:115], v[156:159]
  s_waitcnt lgkmcnt(7)
  v_fma_mix_f32 v66, v61, v50, v52 op_sel_hi:[1,0,0]
  v_and_b32 v62, s28, v64
  v_mfma_f32_16x16x32_bf16 v[164:167], v[20:23], v[116:119], v[164:167]
  ds_read_b128 v[100:103], v79 offset:18432
  v_and_b32 v63, s29, v64
  v_mfma_f32_16x16x32_bf16 v[160:163], v[16:19], v[116:119], v[160:163]
  s_waitcnt lgkmcnt(6)
  v_fma_mix_f32 v67, v60, v48, v52 op_sel:[1,0,0] op_sel_hi:[1,0,0]
  v_fma_mix_f32 v68, v61, v50, v52 op_sel:[1,0,0] op_sel_hi:[1,0,0]
  v_mfma_f32_16x16x32_bf16 v[168:171], v[16:19], v[120:123], v[168:171]
  ds_read_b128 v[104:107], v79 offset:20480
  v_cvt_pk_bf16_f32 v32, v65, v66
  v_mfma_f32_16x16x32_bf16 v[172:175], v[20:23], v[120:123], v[172:175]
  s_waitcnt lgkmcnt(6)
  v_fma_mix_f32 v65, v62, v48, v52 op_sel_hi:[1,0,0]
  v_fma_mix_f32 v66, v63, v50, v52 op_sel_hi:[1,0,0]
  v_mfma_f32_16x16x32_bf16 v[180:183], v[20:23], v[124:127], v[180:183]
  ds_read_b128 v[108:111], v79 offset:22528
  v_cvt_pk_bf16_f32 v34, v67, v68
  v_mfma_f32_16x16x32_bf16 v[176:179], v[16:19], v[124:127], v[176:179]
  s_waitcnt lgkmcnt(6)
  v_fma_mix_f32 v67, v62, v48, v52 op_sel:[1,0,0] op_sel_hi:[1,0,0]
  v_fma_mix_f32 v68, v63, v50, v52 op_sel:[1,0,0] op_sel_hi:[1,0,0]
  v_mfma_f32_16x16x32_bf16 v[184:187], v[16:19], v[88:91], v[184:187]
  ds_read_b128 v[112:115], v79 offset:24576
  v_cvt_pk_bf16_f32 v33, v65, v66
  v_mfma_f32_16x16x32_bf16 v[188:191], v[20:23], v[88:91], v[188:191]
  s_waitcnt lgkmcnt(6)
  v_cvt_pk_bf16_f32 v35, v67, v68
  v_and_b32 v69, s28, v47
  v_mfma_f32_16x16x32_bf16 v[196:199], v[20:23], v[92:95], v[196:199]
  ds_read_b128 v[116:119], v79 offset:26624
  v_and_b32 v70, s29, v47
  v_mfma_f32_16x16x32_bf16 v[192:195], v[16:19], v[92:95], v[192:195]
  s_waitcnt lgkmcnt(5)
  v_lshrrev_b32 v73, 8, v47
  v_fma_mix_f32 v74, v69, v49, v53 op_sel_hi:[1,0,0]
  v_mfma_f32_16x16x32_bf16 v[200:203], v[16:19], v[96:99], v[200:203]
  s_barrier
  ds_read_b128 v[120:123], v78 offset:34816
  v_fma_mix_f32 v75, v70, v51, v53 op_sel_hi:[1,0,0]
  v_mfma_f32_16x16x32_bf16 v[204:207], v[20:23], v[96:99], v[204:207]
  s_waitcnt lgkmcnt(5)
  ds_read2st64_b32 v[40:41], v80 offset0:136 offset1:137
  v_and_b32 v71, s28, v73
  v_mfma_f32_16x16x32_bf16 v[212:215], v[20:23], v[100:103], v[212:215]
  ds_read_b128 v[88:91], v78 offset:36864
  v_and_b32 v72, s29, v73
  v_mfma_f32_16x16x32_bf16 v[208:211], v[16:19], v[100:103], v[208:211]
  s_waitcnt lgkmcnt(6)
  ds_read2st64_b32 v[42:43], v80 offset0:144 offset1:145
  v_fma_mix_f32 v76, v69, v49, v53 op_sel:[1,0,0] op_sel_hi:[1,0,0]
  v_mfma_f32_16x16x32_bf16 v[216:219], v[16:19], v[104:107], v[216:219]
  ds_read_b128 v[92:95], v78 offset:38912
  v_fma_mix_f32 v77, v70, v51, v53 op_sel:[1,0,0] op_sel_hi:[1,0,0]
  v_mfma_f32_16x16x32_bf16 v[220:223], v[20:23], v[104:107], v[220:223]
  s_waitcnt lgkmcnt(7)
  v_cvt_pk_bf16_f32 v36, v74, v75
  v_fma_mix_f32 v74, v71, v49, v53 op_sel_hi:[1,0,0]
  v_mfma_f32_16x16x32_bf16 v[228:231], v[20:23], v[108:111], v[228:231]
  ds_read_b128 v[96:99], v78 offset:40960
  v_fma_mix_f32 v75, v72, v51, v53 op_sel_hi:[1,0,0]
  v_mfma_f32_16x16x32_bf16 v[224:227], v[16:19], v[108:111], v[224:227]
  s_waitcnt lgkmcnt(7)
  v_cvt_pk_bf16_f32 v38, v76, v77
  v_fma_mix_f32 v76, v71, v49, v53 op_sel:[1,0,0] op_sel_hi:[1,0,0]
  v_mfma_f32_16x16x32_bf16 v[232:235], v[16:19], v[112:115], v[232:235]
  s_sub_u32 s37, s37, 1
  ds_read_b128 v[100:103], v78 offset:43008
  v_fma_mix_f32 v77, v72, v51, v53 op_sel:[1,0,0] op_sel_hi:[1,0,0]
  v_mfma_f32_16x16x32_bf16 v[236:239], v[20:23], v[112:115], v[236:239]
  s_waitcnt lgkmcnt(7)
  v_cvt_pk_bf16_f32 v37, v74, v75
  v_cvt_pk_bf16_f32 v39, v76, v77
  v_mfma_f32_16x16x32_bf16 v[244:247], v[20:23], v[116:119], v[244:247]
  s_waitcnt lgkmcnt(6)
  ds_read_b128 v[104:107], v78 offset:45056
  v_mfma_f32_16x16x32_bf16 v[240:243], v[16:19], v[116:119], v[240:243]
  v_xor_b32 v80, s44, v80
  s_cbranch_scc1 FAN
  v_mfma_f32_16x16x32_bf16 v[136:139], v[24:27], v[120:123], v[136:139]
  ds_read_b128 v[108:111], v78 offset:47104
  v_mul_f32 v48, s54, v54
  v_mfma_f32_16x16x32_bf16 v[140:143], v[28:31], v[120:123], v[140:143]
  s_waitcnt lgkmcnt(6)
  v_mul_f32 v52, -v56, v54
  v_mul_f32 v50, s55, v54
  v_mfma_f32_16x16x32_bf16 v[148:151], v[28:31], v[88:91], v[148:151]
  ds_read_b128 v[112:115], v78 offset:49152
  v_mul_f32 v49, s54, v55
  v_mfma_f32_16x16x32_bf16 v[144:147], v[24:27], v[88:91], v[144:147]
  s_waitcnt lgkmcnt(5)
  v_mul_f32 v53, -v57, v55
  v_mul_f32 v51, s55, v55
  v_mfma_f32_16x16x32_bf16 v[152:155], v[24:27], v[92:95], v[152:155]
  ds_read_b128 v[116:119], v78 offset:51200
  v_and_b32 v60, s28, v40
  v_mfma_f32_16x16x32_bf16 v[156:159], v[28:31], v[92:95], v[156:159]
  s_waitcnt lgkmcnt(5)
  v_and_b32 v61, s29, v40
  v_lshrrev_b32 v64, 8, v40
  v_mfma_f32_16x16x32_bf16 v[164:167], v[28:31], v[96:99], v[164:167]
  ds_read_b128 v[120:123], v78 offset:53248
  v_fma_mix_f32 v65, v60, v48, v52 op_sel_hi:[1,0,0]
  v_mfma_f32_16x16x32_bf16 v[160:163], v[24:27], v[96:99], v[160:163]
  s_waitcnt lgkmcnt(5)
  v_fma_mix_f32 v66, v61, v50, v52 op_sel_hi:[1,0,0]
  v_and_b32 v62, s28, v64
  v_mfma_f32_16x16x32_bf16 v[168:171], v[24:27], v[100:103], v[168:171]
  ds_read_b128 v[88:91], v78 offset:55296
  v_and_b32 v63, s29, v64
  v_mfma_f32_16x16x32_bf16 v[172:175], v[28:31], v[100:103], v[172:175]
  s_waitcnt lgkmcnt(5)
  ds_read_u16_d16_hi v54, v81 offset:256
  v_fma_mix_f32 v67, v60, v48, v52 op_sel:[1,0,0] op_sel_hi:[1,0,0]
  v_mfma_f32_16x16x32_bf16 v[180:183], v[28:31], v[104:107], v[180:183]
  ds_read_b128 v[92:95], v78 offset:57344
  v_fma_mix_f32 v68, v61, v50, v52 op_sel:[1,0,0] op_sel_hi:[1,0,0]
  v_mfma_f32_16x16x32_bf16 v[176:179], v[24:27], v[104:107], v[176:179]
  s_waitcnt lgkmcnt(6)
  v_cvt_pk_bf16_f32 v8, v65, v66
  v_fma_mix_f32 v65, v62, v48, v52 op_sel_hi:[1,0,0]
  v_mfma_f32_16x16x32_bf16 v[184:187], v[24:27], v[108:111], v[184:187]
  ds_read_b128 v[96:99], v78 offset:59392
  v_fma_mix_f32 v66, v63, v50, v52 op_sel_hi:[1,0,0]
  v_mfma_f32_16x16x32_bf16 v[188:191], v[28:31], v[108:111], v[188:191]
  s_waitcnt lgkmcnt(6)
  v_cvt_pk_bf16_f32 v10, v67, v68
  v_fma_mix_f32 v67, v62, v48, v52 op_sel:[1,0,0] op_sel_hi:[1,0,0]
  v_mfma_f32_16x16x32_bf16 v[196:199], v[28:31], v[112:115], v[196:199]
  ds_read_b128 v[100:103], v78 offset:61440
  v_fma_mix_f32 v68, v63, v50, v52 op_sel:[1,0,0] op_sel_hi:[1,0,0]
  v_mfma_f32_16x16x32_bf16 v[192:195], v[24:27], v[112:115], v[192:195]
  s_waitcnt lgkmcnt(6)
  v_cvt_pk_bf16_f32 v9, v65, v66
  v_xor_b32 v78, s43, v78
  v_mfma_f32_16x16x32_bf16 v[200:203], v[24:27], v[116:119], v[200:203]
  ds_read_b128 v[104:107], v79 offset:34816
  v_cvt_pk_bf16_f32 v11, v67, v68
  v_mfma_f32_16x16x32_bf16 v[204:207], v[28:31], v[116:119], v[204:207]
  s_waitcnt lgkmcnt(6)
  ds_read_u16_d16_hi v55, v81 offset:384
  v_and_b32 v69, s28, v41
  v_mfma_f32_16x16x32_bf16 v[212:215], v[28:31], v[120:123], v[212:215]
  ds_read_b128 v[108:111], v79 offset:36864
  v_and_b32 v70, s29, v41
  v_mfma_f32_16x16x32_bf16 v[208:211], v[24:27], v[120:123], v[208:211]
  s_waitcnt lgkmcnt(7)
  v_lshrrev_b32 v73, 8, v41
  v_fma_mix_f32 v74, v69, v49, v53 op_sel_hi:[1,0,0]
  v_mfma_f32_16x16x32_bf16 v[216:219], v[24:27], v[88:91], v[216:219]
  ds_read_b128 v[112:115], v79 offset:38912
  v_fma_mix_f32 v75, v70, v51, v53 op_sel_hi:[1,0,0]
  v_mfma_f32_16x16x32_bf16 v[220:223], v[28:31], v[88:91], v[220:223]
  s_waitcnt lgkmcnt(6)
  v_and_b32 v71, s28, v73
  v_and_b32 v72, s29, v73
  v_mfma_f32_16x16x32_bf16 v[228:231], v[28:31], v[92:95], v[228:231]
  ds_read_b128 v[116:119], v79 offset:40960
  v_fma_mix_f32 v76, v69, v49, v53 op_sel:[1,0,0] op_sel_hi:[1,0,0]
  v_mfma_f32_16x16x32_bf16 v[224:227], v[24:27], v[92:95], v[224:227]
  s_waitcnt lgkmcnt(6)
  ds_read_u16_d16_hi v56, v81 offset:4352
  v_fma_mix_f32 v77, v70, v51, v53 op_sel:[1,0,0] op_sel_hi:[1,0,0]
  v_mfma_f32_16x16x32_bf16 v[232:235], v[24:27], v[96:99], v[232:235]
  ds_read_b128 v[120:123], v79 offset:43008
  v_cvt_pk_bf16_f32 v12, v74, v75
  v_mfma_f32_16x16x32_bf16 v[236:239], v[28:31], v[96:99], v[236:239]
  s_waitcnt lgkmcnt(7)
  v_fma_mix_f32 v74, v71, v49, v53 op_sel_hi:[1,0,0]
  v_fma_mix_f32 v75, v72, v51, v53 op_sel_hi:[1,0,0]
  v_mfma_f32_16x16x32_bf16 v[244:247], v[28:31], v[100:103], v[244:247]
  ds_read_b128 v[88:91], v79 offset:45056
  v_cvt_pk_bf16_f32 v14, v76, v77
  v_mfma_f32_16x16x32_bf16 v[240:243], v[24:27], v[100:103], v[240:243]
  s_waitcnt lgkmcnt(7)
  v_fma_mix_f32 v76, v71, v49, v53 op_sel:[1,0,0] op_sel_hi:[1,0,0]
  v_fma_mix_f32 v77, v72, v51, v53 op_sel:[1,0,0] op_sel_hi:[1,0,0]
  v_mfma_f32_16x16x32_bf16 v[136:139], v[32:35], v[104:107], v[136:139]
  ds_read_b128 v[92:95], v79 offset:47104
  v_cvt_pk_bf16_f32 v13, v74, v75
  v_mfma_f32_16x16x32_bf16 v[140:143], v[36:39], v[104:107], v[140:143]
  s_waitcnt lgkmcnt(6)
  v_cvt_pk_bf16_f32 v15, v76, v77
  v_and_b32 v60, s28, v42
  v_mfma_f32_16x16x32_bf16 v[148:151], v[36:39], v[108:111], v[148:151]
  ds_read_b128 v[96:99], v79 offset:49152
  v_and_b32 v61, s29, v42
  v_mfma_f32_16x16x32_bf16 v[144:147], v[32:35], v[108:111], v[144:147]
  s_waitcnt lgkmcnt(6)
  ds_read_u16_d16_hi v57, v81 offset:4480
  v_lshrrev_b32 v64, 8, v42
  v_mfma_f32_16x16x32_bf16 v[152:155], v[32:35], v[112:115], v[152:155]
  ds_read_b128 v[100:103], v79 offset:51200
  v_fma_mix_f32 v65, v60, v48, v52 op_sel_hi:[1,0,0]
  v_mfma_f32_16x16x32_bf16 v[156:159], v[36:39], v[112:115], v[156:159]
  s_waitcnt lgkmcnt(7)
  v_fma_mix_f32 v66, v61, v50, v52 op_sel_hi:[1,0,0]
  v_and_b32 v62, s28, v64
  v_mfma_f32_16x16x32_bf16 v[164:167], v[36:39], v[116:119], v[164:167]
  ds_read_b128 v[104:107], v79 offset:53248
  v_and_b32 v63, s29, v64
  v_mfma_f32_16x16x32_bf16 v[160:163], v[32:35], v[116:119], v[160:163]
  s_waitcnt lgkmcnt(6)
  v_fma_mix_f32 v67, v60, v48, v52 op_sel:[1,0,0] op_sel_hi:[1,0,0]
  v_fma_mix_f32 v68, v61, v50, v52 op_sel:[1,0,0] op_sel_hi:[1,0,0]
  v_mfma_f32_16x16x32_bf16 v[168:171], v[32:35], v[120:123], v[168:171]
  ds_read_b128 v[108:111], v79 offset:55296
  v_cvt_pk_bf16_f32 v16, v65, v66
  v_mfma_f32_16x16x32_bf16 v[172:175], v[36:39], v[120:123], v[172:175]
  s_waitcnt lgkmcnt(6)
  v_fma_mix_f32 v65, v62, v48, v52 op_sel_hi:[1,0,0]
  v_fma_mix_f32 v66, v63, v50, v52 op_sel_hi:[1,0,0]
  v_mfma_f32_16x16x32_bf16 v[180:183], v[36:39], v[88:91], v[180:183]
  ds_read_b128 v[112:115], v79 offset:57344
  v_cvt_pk_bf16_f32 v18, v67, v68
  v_mfma_f32_16x16x32_bf16 v[176:179], v[32:35], v[88:91], v[176:179]
  s_waitcnt lgkmcnt(6)
  v_fma_mix_f32 v67, v62, v48, v52 op_sel:[1,0,0] op_sel_hi:[1,0,0]
  v_fma_mix_f32 v68, v63, v50, v52 op_sel:[1,0,0] op_sel_hi:[1,0,0]
  v_mfma_f32_16x16x32_bf16 v[184:187], v[32:35], v[92:95], v[184:187]
  ds_read_b128 v[116:119], v79 offset:59392
  v_cvt_pk_bf16_f32 v17, v65, v66
  v_mfma_f32_16x16x32_bf16 v[188:191], v[36:39], v[92:95], v[188:191]
  s_waitcnt lgkmcnt(6)
  v_cvt_pk_bf16_f32 v19, v67, v68
  v_and_b32 v69, s28, v43
  v_mfma_f32_16x16x32_bf16 v[196:199], v[36:39], v[96:99], v[196:199]
  ds_read_b128 v[120:123], v79 offset:61440
  v_and_b32 v70, s29, v43
  v_mfma_f32_16x16x32_bf16 v[192:195], v[32:35], v[96:99], v[192:195]
  s_waitcnt lgkmcnt(5)
  v_lshrrev_b32 v73, 8, v43
  v_xor_b32 v79, s43, v79
  v_mfma_f32_16x16x32_bf16 v[200:203], v[32:35], v[100:103], v[200:203]
  s_barrier
  ds_read_b128 v[88:91], v78 offset:0
  v_fma_mix_f32 v74, v69, v49, v53 op_sel_hi:[1,0,0]
  v_mfma_f32_16x16x32_bf16 v[204:207], v[36:39], v[100:103], v[204:207]
  s_waitcnt lgkmcnt(5)
  ds_read2st64_b32 v[44:45], v80 offset0:0 offset1:1
  v_fma_mix_f32 v75, v70, v51, v53 op_sel_hi:[1,0,0]
  v_mfma_f32_16x16x32_bf16 v[212:215], v[36:39], v[104:107], v[212:215]
  ds_read_b128 v[92:95], v78 offset:2048
  v_and_b32 v71, s28, v73
  v_mfma_f32_16x16x32_bf16 v[208:211], v[32:35], v[104:107], v[208:211]
  s_waitcnt lgkmcnt(6)
  ds_read2st64_b32 v[46:47], v80 offset0:8 offset1:9
  v_and_b32 v72, s29, v73
  v_mfma_f32_16x16x32_bf16 v[216:219], v[32:35], v[108:111], v[216:219]
  ds_read_b128 v[96:99], v78 offset:4096
  v_fma_mix_f32 v76, v69, v49, v53 op_sel:[1,0,0] op_sel_hi:[1,0,0]
  v_mfma_f32_16x16x32_bf16 v[220:223], v[36:39], v[108:111], v[220:223]
  s_waitcnt lgkmcnt(7)
  v_fma_mix_f32 v77, v70, v51, v53 op_sel:[1,0,0] op_sel_hi:[1,0,0]
  v_cvt_pk_bf16_f32 v20, v74, v75
  v_mfma_f32_16x16x32_bf16 v[228:231], v[36:39], v[112:115], v[228:231]
  ds_read_b128 v[100:103], v78 offset:6144
  v_fma_mix_f32 v74, v71, v49, v53 op_sel_hi:[1,0,0]
  v_mfma_f32_16x16x32_bf16 v[224:227], v[32:35], v[112:115], v[224:227]
  s_waitcnt lgkmcnt(7)
  v_fma_mix_f32 v75, v72, v51, v53 op_sel_hi:[1,0,0]
  v_cvt_pk_bf16_f32 v22, v76, v77
  v_mfma_f32_16x16x32_bf16 v[232:235], v[32:35], v[116:119], v[232:235]
  ds_read_b128 v[104:107], v78 offset:8192
  v_fma_mix_f32 v76, v71, v49, v53 op_sel:[1,0,0] op_sel_hi:[1,0,0]
  v_mfma_f32_16x16x32_bf16 v[236:239], v[36:39], v[116:119], v[236:239]
  s_waitcnt lgkmcnt(7)
  v_fma_mix_f32 v77, v72, v51, v53 op_sel:[1,0,0] op_sel_hi:[1,0,0]
  v_cvt_pk_bf16_f32 v21, v74, v75
  v_mfma_f32_16x16x32_bf16 v[244:247], v[36:39], v[120:123], v[244:247]
  s_waitcnt lgkmcnt(6)
  ds_read_b128 v[108:111], v78 offset:10240
  v_cvt_pk_bf16_f32 v23, v76, v77
  v_mfma_f32_16x16x32_bf16 v[240:243], v[32:35], v[120:123], v[240:243]
  s_branch CLN
.p2align 12
TCN:
  s_branch CP
SPN:
SQN:
  s_endpgm
.p2align 3
FAN:
  v_mfma_f32_16x16x32_bf16 v[136:139], v[24:27], v[120:123], v[136:139]
  ds_read_b128 v[108:111], v79 offset:34816
  v_mul_f32 v48, s54, v54
  v_mul_f32 v52, -v56, v54
  v_mfma_f32_16x16x32_bf16 v[140:143], v[28:31], v[120:123], v[140:143]
  s_waitcnt lgkmcnt(6)
  v_mul_f32 v50, s55, v54
  v_mul_f32 v49, s54, v55
  v_mul_f32 v53, -v57, v55
  v_mfma_f32_16x16x32_bf16 v[144:147], v[24:27], v[88:91], v[144:147]
  ds_read_b128 v[112:115], v82 offset:0
  v_mul_f32 v51, s55, v55
  v_and_b32 v60, s28, v40
  v_mfma_f32_16x16x32_bf16 v[148:151], v[28:31], v[88:91], v[148:151]
  s_waitcnt lgkmcnt(5)
  v_and_b32 v61, s29, v40
  v_lshrrev_b32 v64, 8, v40
  v_fma_mix_f32 v65, v60, v48, v52 op_sel_hi:[1,0,0]
  v_mfma_f32_16x16x32_bf16 v[152:155], v[24:27], v[92:95], v[152:155]
  ds_read_b128 v[116:119], v87 offset:0
  v_fma_mix_f32 v66, v61, v50, v52 op_sel_hi:[1,0,0]
  v_and_b32 v62, s28, v64
  v_mfma_f32_16x16x32_bf16 v[156:159], v[28:31], v[92:95], v[156:159]
  s_waitcnt lgkmcnt(5)
  v_and_b32 v63, s29, v64
  v_fma_mix_f32 v67, v60, v48, v52 op_sel:[1,0,0] op_sel_hi:[1,0,0]
  v_fma_mix_f32 v68, v61, v50, v52 op_sel:[1,0,0] op_sel_hi:[1,0,0]
  v_mfma_f32_16x16x32_bf16 v[160:163], v[24:27], v[96:99], v[160:163]
  ds_read_b128 v[120:123], v79 offset:36864
  v_cvt_pk_bf16_f32 v8, v65, v66
  v_fma_mix_f32 v65, v62, v48, v52 op_sel_hi:[1,0,0]
  v_mfma_f32_16x16x32_bf16 v[164:167], v[28:31], v[96:99], v[164:167]
  s_waitcnt lgkmcnt(5)
  v_fma_mix_f32 v66, v63, v50, v52 op_sel_hi:[1,0,0]
  v_cvt_pk_bf16_f32 v10, v67, v68
  v_fma_mix_f32 v67, v62, v48, v52 op_sel:[1,0,0] op_sel_hi:[1,0,0]
  v_mfma_f32_16x16x32_bf16 v[168:171], v[24:27], v[100:103], v[168:171]
  ds_read_b128 v[88:91], v82 offset:2048
  v_fma_mix_f32 v68, v63, v50, v52 op_sel:[1,0,0] op_sel_hi:[1,0,0]
  v_cvt_pk_bf16_f32 v9, v65, v66
  v_mfma_f32_16x16x32_bf16 v[172:175], v[28:31], v[100:103], v[172:175]
  s_waitcnt lgkmcnt(5)
  v_cvt_pk_bf16_f32 v11, v67, v68
  v_and_b32 v69, s28, v41
  v_and_b32 v70, s29, v41
  v_mfma_f32_16x16x32_bf16 v[176:179], v[24:27], v[104:107], v[176:179]
  ds_read_b128 v[92:95], v87 offset:2048
  v_lshrrev_b32 v73, 8, v41
  v_fma_mix_f32 v74, v69, v49, v53 op_sel_hi:[1,0,0]
  v_mfma_f32_16x16x32_bf16 v[180:183], v[28:31], v[104:107], v[180:183]
  s_waitcnt lgkmcnt(5)
  v_fma_mix_f32 v75, v70, v51, v53 op_sel_hi:[1,0,0]
  v_and_b32 v71, s28, v73
  v_and_b32 v72, s29, v73
  v_mfma_f32_16x16x32_bf16 v[136:139], v[32:35], v[108:111], v[136:139]
  ds_read_b128 v[96:99], v79 offset:38912
  v_fma_mix_f32 v76, v69, v49, v53 op_sel:[1,0,0] op_sel_hi:[1,0,0]
  v_fma_mix_f32 v77, v70, v51, v53 op_sel:[1,0,0] op_sel_hi:[1,0,0]
  v_mfma_f32_16x16x32_bf16 v[140:143], v[36:39], v[108:111], v[140:143]
  s_waitcnt lgkmcnt(5)
  v_cvt_pk_bf16_f32 v12, v74, v75
  v_fma_mix_f32 v74, v71, v49, v53 op_sel_hi:[1,0,0]
  v_fma_mix_f32 v75, v72, v51, v53 op_sel_hi:[1,0,0]
  v_mfma_f32_16x16x32_bf16 v[136:139], v[0:3], v[112:115], v[136:139]
  ds_read_b128 v[100:103], v82 offset:4096
  v_cvt_pk_bf16_f32 v14, v76, v77
  v_fma_mix_f32 v76, v71, v49, v53 op_sel:[1,0,0] op_sel_hi:[1,0,0]
  v_mfma_f32_16x16x32_bf16 v[140:143], v[4:7], v[112:115], v[140:143]
  s_waitcnt lgkmcnt(5)
  v_fma_mix_f32 v77, v72, v51, v53 op_sel:[1,0,0] op_sel_hi:[1,0,0]
  v_cvt_pk_bf16_f32 v13, v74, v75
  v_cvt_pk_bf16_f32 v15, v76, v77
  v_mfma_f32_16x16x32_bf16 v[136:139], v[128:131], v[116:119], v[136:139]
  ds_read_b128 v[104:107], v82 offset:20480
  v_and_b32 v60, s28, v42
  v_and_b32 v61, s29, v42
  v_mfma_f32_16x16x32_bf16 v[140:143], v[132:135], v[116:119], v[140:143]
  s_waitcnt lgkmcnt(5)
  v_lshrrev_b32 v64, 8, v42
  v_fma_mix_f32 v65, v60, v48, v52 op_sel_hi:[1,0,0]
  v_fma_mix_f32 v66, v61, v50, v52 op_sel_hi:[1,0,0]
  v_mfma_f32_16x16x32_bf16 v[144:147], v[32:35], v[120:123], v[144:147]
  ds_read_b128 v[108:111], v87 offset:20480
  v_and_b32 v62, s28, v64
  v_and_b32 v63, s29, v64
  v_mfma_f32_16x16x32_bf16 v[148:151], v[36:39], v[120:123], v[148:151]
  s_waitcnt lgkmcnt(5)
  v_fma_mix_f32 v67, v60, v48, v52 op_sel:[1,0,0] op_sel_hi:[1,0,0]
  v_fma_mix_f32 v68, v61, v50, v52 op_sel:[1,0,0] op_sel_hi:[1,0,0]
  v_cvt_pk_bf16_f32 v16, v65, v66
  v_mfma_f32_16x16x32_bf16 v[144:147], v[0:3], v[88:91], v[144:147]
  ds_read_b128 v[112:115], v82 offset:22528
  v_fma_mix_f32 v65, v62, v48, v52 op_sel_hi:[1,0,0]
  v_fma_mix_f32 v66, v63, v50, v52 op_sel_hi:[1,0,0]
  v_mfma_f32_16x16x32_bf16 v[148:151], v[4:7], v[88:91], v[148:151]
  s_waitcnt lgkmcnt(5)
  v_cvt_pk_bf16_f32 v18, v67, v68
  v_fma_mix_f32 v67, v62, v48, v52 op_sel:[1,0,0] op_sel_hi:[1,0,0]
  v_fma_mix_f32 v68, v63, v50, v52 op_sel:[1,0,0] op_sel_hi:[1,0,0]
  v_mfma_f32_16x16x32_bf16 v[144:147], v[128:131], v[92:95], v[144:147]
  ds_read_b128 v[116:119], v87 offset:22528
  v_cvt_pk_bf16_f32 v17, v65, v66
  v_cvt_pk_bf16_f32 v19, v67, v68
  v_mfma_f32_16x16x32_bf16 v[148:151], v[132:135], v[92:95], v[148:151]
  s_waitcnt lgkmcnt(5)
  v_and_b32 v69, s28, v43
  v_and_b32 v70, s29, v43
  v_lshrrev_b32 v73, 8, v43
  v_mfma_f32_16x16x32_bf16 v[152:155], v[32:35], v[96:99], v[152:155]
  ds_read_b128 v[120:123], v87 offset:4096
  v_fma_mix_f32 v74, v69, v49, v53 op_sel_hi:[1,0,0]
  v_fma_mix_f32 v75, v70, v51, v53 op_sel_hi:[1,0,0]
  v_mfma_f32_16x16x32_bf16 v[156:159], v[36:39], v[96:99], v[156:159]
  s_waitcnt lgkmcnt(5)
  v_and_b32 v71, s28, v73
  v_and_b32 v72, s29, v73
  v_fma_mix_f32 v76, v69, v49, v53 op_sel:[1,0,0] op_sel_hi:[1,0,0]
  v_mfma_f32_16x16x32_bf16 v[152:155], v[0:3], v[100:103], v[152:155]
  ds_read_b128 v[88:91], v82 offset:24576
  v_fma_mix_f32 v77, v70, v51, v53 op_sel:[1,0,0] op_sel_hi:[1,0,0]
  v_cvt_pk_bf16_f32 v20, v74, v75
  v_mfma_f32_16x16x32_bf16 v[156:159], v[4:7], v[100:103], v[156:159]
  s_waitcnt lgkmcnt(5)
  v_fma_mix_f32 v74, v71, v49, v53 op_sel_hi:[1,0,0]
  v_fma_mix_f32 v75, v72, v51, v53 op_sel_hi:[1,0,0]
  v_cvt_pk_bf16_f32 v22, v76, v77
  v_mfma_f32_16x16x32_bf16 v[136:139], v[8:11], v[104:107], v[136:139]
  ds_read_b128 v[92:95], v87 offset:24576
  v_fma_mix_f32 v76, v71, v49, v53 op_sel:[1,0,0] op_sel_hi:[1,0,0]
  v_fma_mix_f32 v77, v72, v51, v53 op_sel:[1,0,0] op_sel_hi:[1,0,0]
  v_mfma_f32_16x16x32_bf16 v[140:143], v[12:15], v[104:107], v[140:143]
  s_waitcnt lgkmcnt(5)
  v_cvt_pk_bf16_f32 v21, v74, v75
  v_cvt_pk_bf16_f32 v23, v76, v77
  v_mfma_f32_16x16x32_bf16 v[136:139], v[16:19], v[108:111], v[136:139]
T1N:
  s_cbranch_vccnz LW
  ds_read_b128 v[96:99], v79 offset:40960
  v_mfma_f32_16x16x32_bf16 v[140:143], v[20:23], v[108:111], v[140:143]
  s_waitcnt lgkmcnt(5)
  v_mfma_f32_16x16x32_bf16 v[144:147], v[8:11], v[112:115], v[144:147]
  ds_read_b128 v[100:103], v82 offset:6144
  v_mfma_f32_16x16x32_bf16 v[148:151], v[12:15], v[112:115], v[148:151]
  s_waitcnt lgkmcnt(5)
  v_mfma_f32_16x16x32_bf16 v[144:147], v[16:19], v[116:119], v[144:147]
  ds_read_b128 v[104:107], v87 offset:6144
  v_mfma_f32_16x16x32_bf16 v[148:151], v[20:23], v[116:119], v[148:151]
  s_waitcnt lgkmcnt(5)
  v_cvt_pk_bf16_f32 v136, v136, v137
  v_cvt_pk_bf16_f32 v137, v138, v139
  v_mfma_f32_16x16x32_bf16 v[152:155], v[128:131], v[120:123], v[152:155]
  ds_read_b128 v[108:111], v82 offset:26624
  v_cvt_pk_bf16_f32 v138, v140, v141
  v_mfma_f32_16x16x32_bf16 v[156:159], v[132:135], v[120:123], v[156:159]
  s_waitcnt lgkmcnt(5)
  v_cvt_pk_bf16_f32 v139, v142, v143
  v_cvt_pk_bf16_f32 v144, v144, v145
  v_mfma_f32_16x16x32_bf16 v[152:155], v[8:11], v[88:91], v[152:155]
  ds_read_b128 v[112:115], v87 offset:26624
  v_cvt_pk_bf16_f32 v145, v146, v147
  v_mfma_f32_16x16x32_bf16 v[156:159], v[12:15], v[88:91], v[156:159]
  s_waitcnt lgkmcnt(5)
  ds_write_b64 v83, v[136:137] offset:0
  v_cvt_pk_bf16_f32 v146, v148, v149
  v_mfma_f32_16x16x32_bf16 v[152:155], v[16:19], v[92:95], v[152:155]
  ds_read_b128 v[116:119], v79 offset:43008
  v_cvt_pk_bf16_f32 v147, v150, v151
  v_mfma_f32_16x16x32_bf16 v[156:159], v[20:23], v[92:95], v[156:159]
  s_waitcnt lgkmcnt(6)
  ds_write_b64 v86, v[138:139] offset:2048
  v_mfma_f32_16x16x32_bf16 v[160:163], v[32:35], v[96:99], v[160:163]
  ds_read_b128 v[120:123], v82 offset:8192
  v_mfma_f32_16x16x32_bf16 v[164:167], v[36:39], v[96:99], v[164:167]
  s_waitcnt lgkmcnt(7)
  ds_write_b64 v83, v[144:145] offset:4096
  v_mfma_f32_16x16x32_bf16 v[160:163], v[0:3], v[100:103], v[160:163]
  ds_read_b128 v[88:91], v87 offset:8192
  v_cvt_pk_bf16_f32 v152, v152, v153
  v_mfma_f32_16x16x32_bf16 v[164:167], v[4:7], v[100:103], v[164:167]
  s_waitcnt lgkmcnt(8)
  ds_write_b64 v86, v[146:147] offset:6144
  v_cvt_pk_bf16_f32 v153, v154, v155
  v_mfma_f32_16x16x32_bf16 v[160:163], v[128:131], v[104:107], v[160:163]
  ds_read_b128 v[92:95], v82 offset:28672
  v_cvt_pk_bf16_f32 v154, v156, v157
  v_mfma_f32_16x16x32_bf16 v[164:167], v[132:135], v[104:107], v[164:167]
  s_waitcnt lgkmcnt(9)
  v_cvt_pk_bf16_f32 v155, v158, v159
  v_mfma_f32_16x16x32_bf16 v[160:163], v[8:11], v[108:111], v[160:163]
  ds_read_b128 v[96:99], v87 offset:28672
  v_mfma_f32_16x16x32_bf16 v[164:167], v[12:15], v[108:111], v[164:167]
  s_waitcnt lgkmcnt(9)
  ds_write_b64 v83, v[152:153] offset:8192
  v_mfma_f32_16x16x32_bf16 v[160:163], v[16:19], v[112:115], v[160:163]
  ds_read_b128 v[100:103], v79 offset:45056
  v_mfma_f32_16x16x32_bf16 v[164:167], v[20:23], v[112:115], v[164:167]
  s_waitcnt lgkmcnt(9)
  ds_write_b64 v86, v[154:155] offset:10240
  v_mfma_f32_16x16x32_bf16 v[168:171], v[32:35], v[116:119], v[168:171]
  ds_read_b128 v[104:107], v82 offset:10240
  v_mfma_f32_16x16x32_bf16 v[172:175], v[36:39], v[116:119], v[172:175]
  s_waitcnt lgkmcnt(6)
  v_mfma_f32_16x16x32_bf16 v[168:171], v[0:3], v[120:123], v[168:171]
  s_barrier
  ds_read_b128 v[108:111], v87 offset:10240
  v_cvt_pk_bf16_f32 v160, v160, v161
  v_mfma_f32_16x16x32_bf16 v[172:175], v[4:7], v[120:123], v[172:175]
  v_cvt_pk_bf16_f32 v161, v162, v163
  v_cvt_pk_bf16_f32 v162, v164, v165
  v_mfma_f32_16x16x32_bf16 v[168:171], v[128:131], v[88:91], v[168:171]
  ds_read_b128 v[112:115], v82 offset:30720
  v_cvt_pk_bf16_f32 v163, v166, v167
  v_mfma_f32_16x16x32_bf16 v[172:175], v[132:135], v[88:91], v[172:175]
  s_waitcnt lgkmcnt(7)
  ds_write_b64 v83, v[160:161] offset:12288
  v_mfma_f32_16x16x32_bf16 v[168:171], v[8:11], v[92:95], v[168:171]
T2N:
  s_cbranch_vccnz LW
  ds_read_b128 v[116:119], v87 offset:30720
  v_mfma_f32_16x16x32_bf16 v[172:175], v[12:15], v[92:95], v[172:175]
  s_waitcnt lgkmcnt(8)
  ds_write_b64 v86, v[162:163] offset:14336
  v_mfma_f32_16x16x32_bf16 v[168:171], v[16:19], v[96:99], v[168:171]
  ds_read_b128 v[120:123], v78 offset:47104
  v_mfma_f32_16x16x32_bf16 v[172:175], v[20:23], v[96:99], v[172:175]
  s_waitcnt lgkmcnt(8)
  v_mfma_f32_16x16x32_bf16 v[176:179], v[32:35], v[100:103], v[176:179]
  ds_read_b128 v[124:127], v79 offset:47104
  v_mfma_f32_16x16x32_bf16 v[180:183], v[36:39], v[100:103], v[180:183]
  s_waitcnt lgkmcnt(7)
  v_mfma_f32_16x16x32_bf16 v[176:179], v[0:3], v[104:107], v[176:179]
  ds_read_b128 v[88:91], v82 offset:12288
  v_mfma_f32_16x16x32_bf16 v[180:183], v[4:7], v[104:107], v[180:183]
  s_waitcnt lgkmcnt(7)
  v_cvt_pk_bf16_f32 v168, v168, v169
  v_cvt_pk_bf16_f32 v169, v170, v171
  v_mfma_f32_16x16x32_bf16 v[176:179], v[128:131], v[108:111], v[176:179]
  ds_read_b128 v[92:95], v87 offset:12288
  v_cvt_pk_bf16_f32 v170, v172, v173
  v_mfma_f32_16x16x32_bf16 v[180:183], v[132:135], v[108:111], v[180:183]
  s_waitcnt lgkmcnt(4)
  v_cvt_pk_bf16_f32 v171, v174, v175
  v_mfma_f32_16x16x32_bf16 v[176:179], v[8:11], v[112:115], v[176:179]
  s_barrier
  ds_read_b128 v[96:99], v82 offset:32768
  v_mfma_f32_16x16x32_bf16 v[180:183], v[12:15], v[112:115], v[180:183]
  ds_write_b64 v83, v[168:169] offset:16384
  v_mfma_f32_16x16x32_bf16 v[176:179], v[16:19], v[116:119], v[176:179]
  ds_read_b128 v[100:103], v87 offset:32768
  v_mfma_f32_16x16x32_bf16 v[180:183], v[20:23], v[116:119], v[180:183]
  s_waitcnt lgkmcnt(6)
  ds_write_b64 v86, v[170:171] offset:18432
  v_mfma_f32_16x16x32_bf16 v[184:187], v[24:27], v[120:123], v[184:187]
  ds_read_b128 v[104:107], v78 offset:49152
  v_mfma_f32_16x16x32_bf16 v[188:191], v[28:31], v[120:123], v[188:191]
  s_waitcnt lgkmcnt(7)
  v_mfma_f32_16x16x32_bf16 v[184:187], v[32:35], v[124:127], v[184:187]
  ds_read_b128 v[108:111], v79 offset:49152
  v_cvt_pk_bf16_f32 v176, v176, v177
  v_mfma_f32_16x16x32_bf16 v[188:191], v[36:39], v[124:127], v[188:191]
  s_waitcnt lgkmcnt(7)
  v_cvt_pk_bf16_f32 v177, v178, v179
  v_cvt_pk_bf16_f32 v178, v180, v181
  v_mfma_f32_16x16x32_bf16 v[184:187], v[0:3], v[88:91], v[184:187]
  ds_read_b128 v[112:115], v82 offset:14336
  v_cvt_pk_bf16_f32 v179, v182, v183
  v_mfma_f32_16x16x32_bf16 v[188:191], v[4:7], v[88:91], v[188:191]
  s_waitcnt lgkmcnt(7)
  ds_write_b64 v83, v[176:177] offset:20480
  v_mfma_f32_16x16x32_bf16 v[184:187], v[128:131], v[92:95], v[184:187]
  ds_read_b128 v[116:119], v87 offset:14336
  v_mfma_f32_16x16x32_bf16 v[188:191], v[132:135], v[92:95], v[188:191]
  s_waitcnt lgkmcnt(8)
  ds_write_b64 v86, v[178:179] offset:22528
  v_mfma_f32_16x16x32_bf16 v[184:187], v[8:11], v[96:99], v[184:187]
  ds_read_b128 v[120:123], v82 offset:34816
  v_mfma_f32_16x16x32_bf16 v[188:191], v[12:15], v[96:99], v[188:191]
  s_waitcnt lgkmcnt(8)
  v_mfma_f32_16x16x32_bf16 v[184:187], v[16:19], v[100:103], v[184:187]
  ds_read_b128 v[124:127], v87 offset:34816
  v_mfma_f32_16x16x32_bf16 v[188:191], v[20:23], v[100:103], v[188:191]
  s_waitcnt lgkmcnt(7)
  v_mfma_f32_16x16x32_bf16 v[192:195], v[24:27], v[104:107], v[192:195]
  ds_read_b128 v[88:91], v78 offset:51200
  v_mfma_f32_16x16x32_bf16 v[196:199], v[28:31], v[104:107], v[196:199]
  s_waitcnt lgkmcnt(7)
  v_mfma_f32_16x16x32_bf16 v[192:195], v[32:35], v[108:111], v[192:195]
  ds_read_b128 v[92:95], v79 offset:51200
  v_mfma_f32_16x16x32_bf16 v[196:199], v[36:39], v[108:111], v[196:199]
  s_waitcnt lgkmcnt(4)
  v_cvt_pk_bf16_f32 v184, v184, v185
  v_cvt_pk_bf16_f32 v185, v186, v187
  v_mfma_f32_16x16x32_bf16 v[192:195], v[0:3], v[112:115], v[192:195]
  s_barrier
  ds_read_b128 v[96:99], v82 offset:51200
  v_cvt_pk_bf16_f32 v186, v188, v189
  v_mfma_f32_16x16x32_bf16 v[196:199], v[4:7], v[112:115], v[196:199]
T3N:
  s_cbranch_vccnz LW
  v_cvt_pk_bf16_f32 v187, v190, v191
  v_mfma_f32_16x16x32_bf16 v[192:195], v[128:131], v[116:119], v[192:195]
  ds_read_b128 v[100:103], v87 offset:51200
  v_mfma_f32_16x16x32_bf16 v[196:199], v[132:135], v[116:119], v[196:199]
  s_waitcnt lgkmcnt(5)
  ds_write_b64 v83, v[184:185] offset:24576
  v_mfma_f32_16x16x32_bf16 v[192:195], v[8:11], v[120:123], v[192:195]
  ds_read_b128 v[104:107], v82 offset:36864
  v_mfma_f32_16x16x32_bf16 v[196:199], v[12:15], v[120:123], v[196:199]
  s_waitcnt lgkmcnt(6)
  ds_write_b64 v86, v[186:187] offset:26624
  v_mfma_f32_16x16x32_bf16 v[192:195], v[16:19], v[124:127], v[192:195]
  ds_read_b128 v[108:111], v87 offset:36864
  v_mfma_f32_16x16x32_bf16 v[196:199], v[20:23], v[124:127], v[196:199]
  s_waitcnt lgkmcnt(7)
  v_mfma_f32_16x16x32_bf16 v[200:203], v[24:27], v[88:91], v[200:203]
  ds_read_b128 v[112:115], v78 offset:53248
  v_mfma_f32_16x16x32_bf16 v[204:207], v[28:31], v[88:91], v[204:207]
  s_waitcnt lgkmcnt(7)
  v_mfma_f32_16x16x32_bf16 v[200:203], v[32:35], v[92:95], v[200:203]
  ds_read_b128 v[116:119], v79 offset:53248
  v_mfma_f32_16x16x32_bf16 v[204:207], v[36:39], v[92:95], v[204:207]
  s_waitcnt lgkmcnt(7)
  v_cvt_pk_bf16_f32 v192, v192, v193
  v_cvt_pk_bf16_f32 v193, v194, v195
  v_mfma_f32_16x16x32_bf16 v[200:203], v[0:3], v[96:99], v[200:203]
  ds_read_b128 v[120:123], v82 offset:53248
  v_cvt_pk_bf16_f32 v194, v196, v197
  v_mfma_f32_16x16x32_bf16 v[204:207], v[4:7], v[96:99], v[204:207]
  s_waitcnt lgkmcnt(7)
  v_cvt_pk_bf16_f32 v195, v198, v199
  v_mfma_f32_16x16x32_bf16 v[200:203], v[128:131], v[100:103], v[200:203]
  ds_read_b128 v[88:91], v87 offset:53248
  v_mfma_f32_16x16x32_bf16 v[204:207], v[132:135], v[100:103], v[204:207]
  s_waitcnt lgkmcnt(6)
  ds_write_b64 v83, v[192:193] offset:28672
  v_mfma_f32_16x16x32_bf16 v[200:203], v[8:11], v[104:107], v[200:203]
  ds_read_b128 v[92:95], v82 offset:38912
  v_mfma_f32_16x16x32_bf16 v[204:207], v[12:15], v[104:107], v[204:207]
  s_waitcnt lgkmcnt(6)
  ds_write_b64 v86, v[194:195] offset:30720
  v_mfma_f32_16x16x32_bf16 v[200:203], v[16:19], v[108:111], v[200:203]
  ds_read_b128 v[96:99], v87 offset:38912
  v_mfma_f32_16x16x32_bf16 v[204:207], v[20:23], v[108:111], v[204:207]
  s_waitcnt lgkmcnt(7)
  v_mfma_f32_16x16x32_bf16 v[208:211], v[24:27], v[112:115], v[208:211]
  ds_read_b128 v[100:103], v78 offset:55296
  v_mfma_f32_16x16x32_bf16 v[212:215], v[28:31], v[112:115], v[212:215]
  s_waitcnt lgkmcnt(7)
  v_mfma_f32_16x16x32_bf16 v[208:211], v[32:35], v[116:119], v[208:211]
  ds_read_b128 v[104:107], v79 offset:55296
  v_mfma_f32_16x16x32_bf16 v[212:215], v[36:39], v[116:119], v[212:215]
  s_waitcnt lgkmcnt(7)
  v_cvt_pk_bf16_f32 v200, v200, v201
  v_cvt_pk_bf16_f32 v201, v202, v203
  v_mfma_f32_16x16x32_bf16 v[208:211], v[0:3], v[120:123], v[208:211]
  ds_read_b128 v[108:111], v82 offset:55296
  v_cvt_pk_bf16_f32 v202, v204, v205
  v_mfma_f32_16x16x32_bf16 v[212:215], v[4:7], v[120:123], v[212:215]
  s_waitcnt lgkmcnt(4)
  v_cvt_pk_bf16_f32 v203, v206, v207
  v_mfma_f32_16x16x32_bf16 v[208:211], v[128:131], v[88:91], v[208:211]
  s_barrier
  ds_read_b128 v[112:115], v87 offset:55296
  v_mfma_f32_16x16x32_bf16 v[212:215], v[132:135], v[88:91], v[212:215]
  ds_write_b64 v83, v[200:201] offset:32768
  v_mfma_f32_16x16x32_bf16 v[208:211], v[8:11], v[92:95], v[208:211]
  ds_read_b128 v[116:119], v82 offset:40960
  v_mfma_f32_16x16x32_bf16 v[212:215], v[12:15], v[92:95], v[212:215]
  s_waitcnt lgkmcnt(6)
  ds_write_b64 v86, v[202:203] offset:34816
  v_mfma_f32_16x16x32_bf16 v[208:211], v[16:19], v[96:99], v[208:211]
  ds_read_b128 v[120:123], v87 offset:40960
  v_mfma_f32_16x16x32_bf16 v[212:215], v[20:23], v[96:99], v[212:215]
  s_waitcnt lgkmcnt(7)
  v_mfma_f32_16x16x32_bf16 v[216:219], v[24:27], v[100:103], v[216:219]
  ds_read_b128 v[88:91], v78 offset:57344
  v_mfma_f32_16x16x32_bf16 v[220:223], v[28:31], v[100:103], v[220:223]
  s_waitcnt lgkmcnt(7)
  v_mfma_f32_16x16x32_bf16 v[216:219], v[32:35], v[104:107], v[216:219]
T4N:
  s_cbranch_vccnz LW
  ds_read_b128 v[92:95], v79 offset:57344
  v_cvt_pk_bf16_f32 v208, v208, v209
  v_mfma_f32_16x16x32_bf16 v[220:223], v[36:39], v[104:107], v[220:223]
  s_waitcnt lgkmcnt(7)
  v_cvt_pk_bf16_f32 v209, v210, v211
  v_cvt_pk_bf16_f32 v210, v212, v213
  v_mfma_f32_16x16x32_bf16 v[216:219], v[0:3], v[108:111], v[216:219]
  ds_read_b128 v[96:99], v82 offset:57344
  v_cvt_pk_bf16_f32 v211, v214, v215
  v_mfma_f32_16x16x32_bf16 v[220:223], v[4:7], v[108:111], v[220:223]
  s_waitcnt lgkmcnt(7)
  ds_write_b64 v83, v[208:209] offset:36864
  v_mfma_f32_16x16x32_bf16 v[216:219], v[128:131], v[112:115], v[216:219]
  ds_read_b128 v[100:103], v87 offset:57344
  v_mfma_f32_16x16x32_bf16 v[220:223], v[132:135], v[112:115], v[220:223]
  s_waitcnt lgkmcnt(7)
  ds_write_b64 v86, v[210:211] offset:38912
  v_mfma_f32_16x16x32_bf16 v[216:219], v[8:11], v[116:119], v[216:219]
  ds_read_b128 v[104:107], v82 offset:43008
  v_mfma_f32_16x16x32_bf16 v[220:223], v[12:15], v[116:119], v[220:223]
  s_waitcnt lgkmcnt(7)
  v_mfma_f32_16x16x32_bf16 v[216:219], v[16:19], v[120:123], v[216:219]
  ds_read_b128 v[108:111], v87 offset:43008
  v_mfma_f32_16x16x32_bf16 v[220:223], v[20:23], v[120:123], v[220:223]
  s_waitcnt lgkmcnt(7)
  v_mfma_f32_16x16x32_bf16 v[224:227], v[24:27], v[88:91], v[224:227]
  ds_read_b128 v[112:115], v78 offset:59392
  v_mfma_f32_16x16x32_bf16 v[228:231], v[28:31], v[88:91], v[228:231]
  s_waitcnt lgkmcnt(7)
  v_mfma_f32_16x16x32_bf16 v[224:227], v[32:35], v[92:95], v[224:227]
  ds_read_b128 v[116:119], v79 offset:59392
  v_mfma_f32_16x16x32_bf16 v[228:231], v[36:39], v[92:95], v[228:231]
  s_waitcnt lgkmcnt(4)
  v_cvt_pk_bf16_f32 v216, v216, v217
  v_cvt_pk_bf16_f32 v217, v218, v219
  v_mfma_f32_16x16x32_bf16 v[224:227], v[0:3], v[96:99], v[224:227]
  s_barrier
  ds_read_b128 v[120:123], v82 offset:59392
  v_cvt_pk_bf16_f32 v218, v220, v221
  v_mfma_f32_16x16x32_bf16 v[228:231], v[4:7], v[96:99], v[228:231]
  v_cvt_pk_bf16_f32 v219, v222, v223
  v_mfma_f32_16x16x32_bf16 v[224:227], v[128:131], v[100:103], v[224:227]
  ds_read_b128 v[88:91], v87 offset:59392
  v_mfma_f32_16x16x32_bf16 v[228:231], v[132:135], v[100:103], v[228:231]
  s_waitcnt lgkmcnt(5)
  ds_write_b64 v58, v[216:217] offset:0
  v_mfma_f32_16x16x32_bf16 v[224:227], v[8:11], v[104:107], v[224:227]
  ds_read_b128 v[92:95], v82 offset:45056
  v_mfma_f32_16x16x32_bf16 v[228:231], v[12:15], v[104:107], v[228:231]
  s_waitcnt lgkmcnt(6)
  ds_write_b64 v59, v[218:219] offset:2048
  v_mfma_f32_16x16x32_bf16 v[224:227], v[16:19], v[108:111], v[224:227]
  ds_read_b128 v[96:99], v87 offset:45056
  v_mfma_f32_16x16x32_bf16 v[228:231], v[20:23], v[108:111], v[228:231]
  s_waitcnt lgkmcnt(7)
  v_mfma_f32_16x16x32_bf16 v[232:235], v[24:27], v[112:115], v[232:235]
  ds_read_b128 v[100:103], v78 offset:61440
  v_mfma_f32_16x16x32_bf16 v[236:239], v[28:31], v[112:115], v[236:239]
  s_waitcnt lgkmcnt(7)
  v_mfma_f32_16x16x32_bf16 v[232:235], v[32:35], v[116:119], v[232:235]
  ds_read_b128 v[104:107], v79 offset:61440
  v_mfma_f32_16x16x32_bf16 v[236:239], v[36:39], v[116:119], v[236:239]
  s_waitcnt lgkmcnt(7)
  v_cvt_pk_bf16_f32 v224, v224, v225
  v_cvt_pk_bf16_f32 v225, v226, v227
  v_mfma_f32_16x16x32_bf16 v[232:235], v[0:3], v[120:123], v[232:235]
  ds_read_b128 v[108:111], v82 offset:61440
  v_cvt_pk_bf16_f32 v226, v228, v229
  v_mfma_f32_16x16x32_bf16 v[236:239], v[4:7], v[120:123], v[236:239]
  s_waitcnt lgkmcnt(7)
  v_cvt_pk_bf16_f32 v227, v230, v231
  v_mfma_f32_16x16x32_bf16 v[232:235], v[128:131], v[88:91], v[232:235]
  ds_read_b128 v[112:115], v87 offset:61440
  v_mfma_f32_16x16x32_bf16 v[236:239], v[132:135], v[88:91], v[236:239]
  s_waitcnt lgkmcnt(6)
  ds_write_b64 v58, v[224:225] offset:4096
  v_mfma_f32_16x16x32_bf16 v[232:235], v[8:11], v[92:95], v[232:235]
  ds_read_b128 v[116:119], v82 offset:47104
  v_mfma_f32_16x16x32_bf16 v[236:239], v[12:15], v[92:95], v[236:239]
  s_waitcnt lgkmcnt(6)
  ds_write_b64 v59, v[226:227] offset:6144
  v_mfma_f32_16x16x32_bf16 v[232:235], v[16:19], v[96:99], v[232:235]
T5N:
  s_cbranch_vccnz LW
  ds_read_b128 v[120:123], v87 offset:47104
  v_mfma_f32_16x16x32_bf16 v[236:239], v[20:23], v[96:99], v[236:239]
  s_waitcnt lgkmcnt(7)
  v_mfma_f32_16x16x32_bf16 v[240:243], v[24:27], v[100:103], v[240:243]
  v_mfma_f32_16x16x32_bf16 v[244:247], v[28:31], v[100:103], v[244:247]
  s_waitcnt lgkmcnt(6)
  v_mfma_f32_16x16x32_bf16 v[240:243], v[32:35], v[104:107], v[240:243]
  v_mfma_f32_16x16x32_bf16 v[244:247], v[36:39], v[104:107], v[244:247]
  s_waitcnt lgkmcnt(5)
  v_mfma_f32_16x16x32_bf16 v[240:243], v[0:3], v[108:111], v[240:243]
  v_cvt_pk_bf16_f32 v232, v232, v233
  v_cvt_pk_bf16_f32 v233, v234, v235
  v_mfma_f32_16x16x32_bf16 v[244:247], v[4:7], v[108:111], v[244:247]
  s_waitcnt lgkmcnt(1)
  v_cvt_pk_bf16_f32 v234, v236, v237
  v_cvt_pk_bf16_f32 v235, v238, v239
  v_mfma_f32_16x16x32_bf16 v[240:243], v[128:131], v[112:115], v[240:243]
  s_barrier
  ds_write_b64 v58, v[232:233] offset:8192
  v_mfma_f32_16x16x32_bf16 v[244:247], v[132:135], v[112:115], v[244:247]
  ds_write_b64 v59, v[234:235] offset:10240
  v_mfma_f32_16x16x32_bf16 v[240:243], v[8:11], v[116:119], v[240:243]
  v_mfma_f32_16x16x32_bf16 v[244:247], v[12:15], v[116:119], v[244:247]
  s_waitcnt lgkmcnt(2)
  v_mfma_f32_16x16x32_bf16 v[240:243], v[16:19], v[120:123], v[240:243]
  v_mfma_f32_16x16x32_bf16 v[244:247], v[20:23], v[120:123], v[244:247]
  s_nop 7
  v_cvt_pk_bf16_f32 v240, v240, v241
  v_cvt_pk_bf16_f32 v241, v242, v243
  v_cvt_pk_bf16_f32 v242, v244, v245
  v_cvt_pk_bf16_f32 v243, v246, v247
  ds_write_b64 v58, v[240:241] offset:12288
  ds_write_b64 v59, v[242:243] offset:14336
  s_waitcnt lgkmcnt(0)
  s_barrier
  s_endpgm
.section .rodata,"a"
.p2align 6
.amdhsa_kernel standalone__weight_only_int_gptq__prompt_kernel
  .amdhsa_next_free_vgpr 256
  .amdhsa_next_free_sgpr 64
  .amdhsa_accum_offset 256
  .amdhsa_group_segment_fixed_size 0
  .amdhsa_kernarg_size 64
  .amdhsa_user_sgpr_count 2
  .amdhsa_user_sgpr_kernarg_segment_ptr 1
  .amdhsa_system_sgpr_workgroup_id_x 1
.end_amdhsa_kernel
```
